```python
import torch

def _softmax(x, axis=-1):
    return torch.softmax(x, dim=axis)
def _gelu(x):
    return torch.nn.functional.gelu(x, approximate="tanh")
def _silu(x):
    return torch.nn.functional.silu(x)
def _sigmoid(x):
    return torch.sigmoid(x)
def _layernorm(x, axis=-1, eps=1e-5):
    m = x.mean(dim=axis, keepdim=True)
    v = x.var(dim=axis, keepdim=True, unbiased=False)
    return (x - m) / torch.sqrt(v + eps)
def _scatter_add(tgt, idx, src, axis=0):
    return tgt.clone().index_add_(axis, idx, src)
def _segment_sum(src, seg, n):
    out = torch.zeros((n,) + src.shape[1:], dtype=src.dtype)
    return out.index_add_(0, seg, src)
def _pad(x, pw):
    flat = tuple(v for pair in reversed(pw) for v in pair)
    return torch.nn.functional.pad(x, flat)

kernel_name = 'recurrent_scan__ssm_conv_s4d__moe_arch_mod__prompt'

def setup_inputs():

    _w = (lambda a: (lambda t: t.to(torch.bfloat16) if t.is_floating_point() else t)(torch.as_tensor(a)))
    def _A_setup():
        Bsz, L, D, N = 1, 2048, 640, 128
        return {
            "u": _w((lambda *s: torch.randn(*s, dtype=torch.bfloat16) * 0.05)(Bsz, L, D)),
            "log_A_real": _w((lambda *s: torch.randn(*s, dtype=torch.bfloat16) * 6.4)(D, N) * 0.5),
            "A_imag": _w((lambda *s: torch.randn(*s, dtype=torch.bfloat16) * 0.05)(D, N) * 3.14),
            "C_real": _w((lambda *s: torch.randn(*s, dtype=torch.bfloat16) * 0.05)(D, N) / N ** 0.5),
            "C_imag": _w((lambda *s: torch.randn(*s, dtype=torch.bfloat16) * 0.05)(D, N) / N ** 0.5),
            "log_dt": _w((lambda *s: torch.randn(*s, dtype=torch.bfloat16) * 0.05)(D) * 0.5 - 4.0),
            "D_skip": _w((lambda *s: torch.randn(*s, dtype=torch.bfloat16) * 0.05)(D)),
        }
    _A_in = _A_setup()

    def _B_setup():
        B, S, D, F, C = 1, 2048, 640, 1728, 8
        return {
            "x": _w((lambda *s: torch.randn(*s, dtype=torch.bfloat16) * 0.05)(B, S, D)),
            "w_r": _w((lambda *s: torch.randn(*s, dtype=torch.bfloat16) * 0.05)(D)),
            "w_gate": _w((lambda *s: torch.randn(*s, dtype=torch.bfloat16) * 0.05)(D, F)),
            "w_up": _w((lambda *s: torch.randn(*s, dtype=torch.bfloat16) * 0.05)(D, F)),
            "w_down": _w((lambda *s: torch.randn(*s, dtype=torch.bfloat16) * 0.05)(F, D)),
        }
    _B_in = _B_setup()

    return {
        "A_u": _A_in["u"],
        "A_log_A_real": _A_in["log_A_real"],
        "A_A_imag": _A_in["A_imag"],
        "A_C_real": _A_in["C_real"],
        "A_C_imag": _A_in["C_imag"],
        "A_log_dt": _A_in["log_dt"],
        "A_D_skip": _A_in["D_skip"],
        "B_x": _B_in["x"],
        "B_w_r": _B_in["w_r"],
        "B_w_gate": _B_in["w_gate"],
        "B_w_up": _B_in["w_up"],
        "B_w_down": _B_in["w_down"],
    }

def reference(A_u, A_log_A_real, A_A_imag, A_C_real, A_C_imag, A_log_dt, A_D_skip, B_x, B_w_r, B_w_gate, B_w_up, B_w_down):
    def _A_ref(u, log_A_real, A_imag, C_real, C_imag, log_dt, D_skip):
        L = u.shape[1]
        dt = torch.exp(log_dt)
        A = -torch.exp(log_A_real) + 1j * A_imag
        C = (C_real + 1j * C_imag) * dt[:, None]
        pos = (lambda x, dt: x.to(dt))(torch.arange(L), log_dt.dtype)
        P = torch.exp((A * dt[:, None])[:, :, None] * pos[None, None, :])
        K = 2.0 * torch.einsum("dn,dnl->dl", C, P).real
        L2 = 2 * L
        u_t = (lambda x, *d: x.permute(*d))(u, 0, 2, 1)
        Kf = (lambda x, *a, **k: torch.fft.rfft(x.float(), *a, **k))(K, L2)
        Uf = (lambda x, *a, **k: torch.fft.rfft(x.float(), *a, **k))(u_t, L2)
        y = (lambda x, *a, **k: torch.fft.irfft(x, *a, **k).to(torch.bfloat16))(Uf * Kf[None, :, :], L2)[:, :, :L]
        y = (lambda x, *d: x.permute(*d))(y, 0, 2, 1)
        return y + u * D_skip[None, None, :]

    def _B_ref(x, w_r, w_gate, w_up, w_down):
        B, S, D = x.shape
        C = 8
        r = x @ w_r
        idx = torch.argsort(-r, axis=-1)[:, :C]
        idx_e = (lambda x, n, axis: torch.repeat_interleave(x, n, dim=axis))(idx.reshape(B, C, 1), D, axis=2)
        x_sel = (lambda x, i, axis: torch.take_along_dim(x, i, dim=axis))(x, idx_e, axis=1)
        g = _silu(x_sel @ w_gate)
        u = x_sel @ w_up
        y = (g * u) @ w_down
        r_sel = _sigmoid((lambda x, i, axis: torch.take_along_dim(x, i, dim=axis))(r, idx, axis=1))
        y = y * r_sel.reshape(B, C, 1)
        b_off = (torch.arange(B) * S).reshape(B, 1)
        flat_idx = (idx + b_off).reshape(B * C)
        zero = (x * 0.0).reshape(B * S, D)
        upd = _scatter_add(zero, flat_idx, y.reshape(B * C, D), axis=0)
        return x + upd.reshape(B, S, D)

    x = A_u
    xn = _layernorm(x, axis=-1)
    s = _A_ref(xn, A_log_A_real, A_A_imag, A_C_real, A_C_imag, A_log_dt, A_D_skip)
    g = _silu(_B_ref(xn, B_w_r, B_w_gate, B_w_up, B_w_down))
    return x + s * g
```

```asm
; @launch grid=(256,1,1) block=(512,1,1) lds=160416
.amdgcn_target "amdgcn-amd-amdhsa--gfx950"
.text
.globl recurrent_scan__ssm_conv_s4d__moe_arch_mod__prompt_kernel
.p2align 8
.type recurrent_scan__ssm_conv_s4d__moe_arch_mod__prompt_kernel,@function
recurrent_scan__ssm_conv_s4d__moe_arch_mod__prompt_kernel:
    s_cmp_ge_u32 s2, 256
    s_cbranch_scc1 Lend
    s_load_dwordx16 s[16:31], s[0:1], 0
    s_load_dwordx8 s[32:39], s[0:1], 64
    s_load_dwordx4 s[40:43], s[0:1], 96
    s_load_dwordx2 s[44:45], s[0:1], 112
    v_cmp_gt_u32 vcc, 8, v0
    s_nop 0
    s_and_saveexec_b64 s[62:63], vcc
    s_cbranch_execz Lpcs
    s_getpc_b64 s[100:101]
Lpc0:
    s_sub_u32 s100, s100, Lpc0-recurrent_scan__ssm_conv_s4d__moe_arch_mod__prompt_kernel
    s_subb_u32 s101, s101, 0
    s_lshr_b32 s60, s2, 3
    s_lshl_b32 s60, s60, 10
    v_lshl_add_u32 v2, v0, 7, s60
    v_min_u32 v2, Lend-recurrent_scan__ssm_conv_s4d__moe_arch_mod__prompt_kernel, v2
    global_load_dword v249, v2, s[100:101]
Lpcs:
    s_mov_b64 exec, s[62:63]
    v_lshrrev_b32 v1, 6, v0
    s_nop 0
    v_readfirstlane_b32 s4, v1
    s_mov_b32 s71, s2
    s_and_b32 s62, s2, 7
    s_lshl_b32 s62, s62, 3
    s_lshr_b32 s63, s2, 3
    s_mov_b32 s60, 0x10100808
    s_mov_b32 s61, 0x10100808
    s_lshr_b64 s[60:61], s[60:61], s62
    s_and_b32 s64, s60, 0xff
    s_mov_b32 s60, 0x40301800
    s_mov_b32 s61, 0x90806850
    s_lshr_b64 s[60:61], s[60:61], s62
    s_and_b32 s65, s60, 0xff
    s_sub_u32 s49, s63, s64
    s_add_u32 s2, s65, s49
    s_add_u32 s2, s2, 96
    s_mov_b32 s14, 2621440
    s_mov_b32 s15, 0x00020000
    s_mov_b32 s10, 16777216
    s_mov_b32 s11, 0x00020000
    v_and_b32 v1, 63, v0
    s_cmp_lt_u32 s63, s64
    s_cbranch_scc1 LLL
LCONV:
    s_sub_u32 s46, s2, 96
    s_and_b32 s47, s4, 3
    s_lshl_b32 s6, s46, 2
    s_add_u32 s6, s6, s47
    s_lshl_b32 s7, s6, 8
    v_lshl_add_u32 v7, v1, 2, s7
    s_lshl_b32 s7, s6, 1
    v_mov_b32 v8, s7
    s_mul_i32 s48, s47, 32736
    s_mul_i32 s56, s46, 12
    s_mul_i32 s7, s47, 3
    s_add_u32 s56, s56, s7
    s_mul_i32 s7, s56, 1280
    v_lshlrev_b32 v2, 4, v1
    v_lshlrev_b32 v3, 2, v1
    v_mov_b32 v10, 0
    v_mov_b32 v11, 0
    v_add_u32 v6, 150432, v3
    ds_write_b32 v6, v10
    ds_write_b32 v6, v10 offset:1536
    s_mul_i32 s60, s47, 4608
    s_add_u32 s60, s60, 132000
    v_lshl_add_u32 v6, v1, 3, s60
    ds_write_b64 v6, v[10:11]
    v_lshl_add_u32 v9, v1, 3, s48
    v_add_u32 v3, 1024, v3
    s_waitcnt lgkmcnt(0)
    global_load_ushort v196, v8, s[26:27] nt
    global_load_dword v192, v7, s[18:19] nt
    global_load_dword v193, v7, s[20:21] nt
    s_mov_b32 s12, s16
    s_mov_b32 s13, s17
    s_mov_b32 s8, s44
    s_mov_b32 s9, s45
    s_cmp_lt_u32 s4, 4
    s_cbranch_scc1 LCi
    global_load_dword v194, v7, s[22:23] nt
    global_load_dword v195, v7, s[24:25] nt
    global_load_ushort v254, v8, s[28:29]
LCi:
    s_barrier
    s_cmp_ge_u32 s4, 4
    s_cbranch_scc1 LM
    buffer_load_dwordx4 v[64:67], v2, s[12:15], s7 offen offset:0
    buffer_load_dword v68, v3, s[12:15], s7 offen offset:0
    buffer_load_dwordx4 v[70:73], v2, s[12:15], s7 offen offset:1280
    buffer_load_dword v74, v3, s[12:15], s7 offen offset:1280
    buffer_load_dwordx4 v[76:79], v2, s[12:15], s7 offen offset:2560
    buffer_load_dword v80, v3, s[12:15], s7 offen offset:2560
    global_load_dwordx4 v[82:85], v2, s[32:33]
    global_load_dword v86, v3, s[32:33]
    s_branch LH
LM:
    v_and_b32 v10, 15, v1
    v_lshrrev_b32 v11, 4, v1
    v_lshlrev_b32 v12, 3, v11
    s_lshl_b32 s63, s47, 11
    s_add_u32 s63, s63, 152224
    v_lshl_add_u32 v15, v1, 4, s63
    s_mov_b32 s60, 0xe04030b
    s_mov_b32 s61, 0x0
    s_mul_i32 s62, s47, 8
    s_lshr_b64 s[60:61], s[60:61], s62
    s_and_b32 s60, s60, 255
    v_add_u32 v13, s60, v10
    s_mov_b32 s60, 0x70007
    s_mov_b32 s61, 0x701ff
    s_mul_i32 s62, s47, 16
    s_lshr_b64 s[60:61], s[60:61], s62
    s_and_b32 s60, s60, 65535
    v_mov_b32 v14, s60
    v_lshlrev_b32 v14, v13, v14
    v_lshrrev_b32 v14, v12, v14
    s_mov_b32 s60, 0x3f803f80
    s_mov_b32 s61, 0xffff3f80
    s_mul_i32 s62, s47, 16
    s_lshr_b64 s[60:61], s[60:61], s62
    s_and_b32 s60, s60, 65535
    s_mov_b32 s61, 0x10001
    v_bfe_u32 v20, v14, 0, 2
    v_lshl_or_b32 v20, v20, 15, v20
    v_and_b32 v20, s61, v20
    v_mul_u32_u24 v20, s60, v20
    v_bfe_u32 v21, v14, 2, 2
    v_lshl_or_b32 v21, v21, 15, v21
    v_and_b32 v21, s61, v21
    v_mul_u32_u24 v21, s60, v21
    v_bfe_u32 v22, v14, 4, 2
    v_lshl_or_b32 v22, v22, 15, v22
    v_and_b32 v22, s61, v22
    v_mul_u32_u24 v22, s60, v22
    v_bfe_u32 v23, v14, 6, 2
    v_lshl_or_b32 v23, v23, 15, v23
    v_and_b32 v23, s61, v23
    v_mul_u32_u24 v23, s60, v23
    ds_write_b128 v15, v[20:23] offset:0
    s_mov_b32 s60, 0xc100506
    s_mov_b32 s61, 0x0
    s_mul_i32 s62, s47, 8
    s_lshr_b64 s[60:61], s[60:61], s62
    s_and_b32 s60, s60, 255
    v_add_u32 v13, s60, v10
    s_mov_b32 s60, 0x7f001f
    s_mov_b32 s61, 0x30001
    s_mul_i32 s62, s47, 16
    s_lshr_b64 s[60:61], s[60:61], s62
    s_and_b32 s60, s60, 65535
    v_mov_b32 v14, s60
    v_lshlrev_b32 v14, v13, v14
    v_lshrrev_b32 v14, v12, v14
    s_mov_b32 s60, 0x3f803f80
    s_mov_b32 s61, 0xffffffff
    s_mul_i32 s62, s47, 16
    s_lshr_b64 s[60:61], s[60:61], s62
    s_and_b32 s60, s60, 65535
    s_mov_b32 s61, 0x10001
    v_bfe_u32 v24, v14, 0, 2
    v_lshl_or_b32 v24, v24, 15, v24
    v_and_b32 v24, s61, v24
    v_mul_u32_u24 v24, s60, v24
    v_bfe_u32 v25, v14, 2, 2
    v_lshl_or_b32 v25, v25, 15, v25
    v_and_b32 v25, s61, v25
    v_mul_u32_u24 v25, s60, v25
    v_bfe_u32 v26, v14, 4, 2
    v_lshl_or_b32 v26, v26, 15, v26
    v_and_b32 v26, s61, v26
    v_mul_u32_u24 v26, s60, v26
    v_bfe_u32 v27, v14, 6, 2
    v_lshl_or_b32 v27, v27, 15, v27
    v_and_b32 v27, s61, v27
    v_mul_u32_u24 v27, s60, v27
    ds_write_b128 v15, v[24:27] offset:1024
    s_add_u32 s50, s48, 16896
    v_add_u32 v14, 1, v10
    v_and_b32 v15, 3, v14
    v_mul_u32_u24 v15, 1344, v15
    v_lshrrev_b32 v14, 2, v14
    v_lshlrev_b32 v14, 3, v14
    v_lshl_add_u32 v2, v11, 4, v15
    v_sub_u32 v2, v2, v14
    s_add_u32 s60, s50, 32
    v_add_u32 v2, s60, v2
    v_lshlrev_b32 v14, 2, v11
    v_sub_u32 v14, v10, v14
    s_add_u32 s60, s50, 5376
    v_lshl_add_u32 v3, v14, 4, s60
    s_add_u32 s60, s50, 6400
    v_lshl_add_u32 v4, v14, 3, s60
    s_mul_i32 s60, s47, 4608
    s_add_u32 s60, s60, 132032
    v_lshlrev_b32 v6, 5, v10
    v_lshl_add_u32 v6, v11, 4, v6
    v_add_u32 v6, s60, v6
    v_bfe_u32 v7, v10, 1, 2
    v_xor_b32 v7, v7, v11
    v_lshl_add_u32 v7, v10, 2, v7
    v_lshl_add_u32 v7, v7, 4, s48
    v_and_b32 v13, 31, v1
    v_mul_u32_u24 v242, 528, v13
    v_lshrrev_b32 v12, 5, v1
    v_lshl_add_u32 v242, v12, 4, v242
    v_add_u32 v242, s48, v242
    v_lshlrev_b32 v15, 4, v1
    v_sub_u32 v243, s50, v15
    v_add_u32 v243, 1072, v243
    v_add_u32 v244, 2692, v243
    v_add_u32 v245, 4036, v243
    s_add_u32 s60, s50, 5632
    v_lshl_add_u32 v246, v1, 3, s60
    v_lshlrev_b32 v247, 8, v12
    v_lshl_add_u32 v247, v13, 2, v247
    s_add_u32 s60, s50, 6528
    v_add_u32 v247, s60, v247
    s_add_u32 s60, s50, 5376
    v_add_u32 v248, s60, v15
    v_and_b32 v14, 7, v1
    v_min_u32 v13, 6, v14
    v_cmp_lt_u32 vcc, 4, v13
    v_lshlrev_b32 v13, 4, v13
    v_add_u32 v15, 1008, v13
    v_cndmask_b32 v13, v13, v15, vcc
    v_lshrrev_b32 v15, 3, v1
    v_mul_u32_u24 v15, 1344, v15
    v_add_u32 v13, v13, v15
    v_lshlrev_b32 v14, 4, v14
    v_add_u32 v14, 6400, v14
    v_cmp_lt_u32 vcc, 31, v1
    s_nop 1
    v_cndmask_b32 v13, v13, v14, vcc
    v_add_u32 v249, s50, v13
    s_lshl_b32 s60, s47, 2
    s_add_u32 s60, s60, 150432
    v_mov_b32 v8, s60
    ds_write_b32 v8, v8 offset:240
    v_lshlrev_b32 v251, 4, v1
    v_add_u32 v251, 152224, v251
    v_mov_b32 v16, 0
    v_mov_b32 v17, 0
    v_mov_b32 v18, 0
    v_mov_b32 v19, 0
    s_waitcnt vmcnt(0)
LMu:
    s_mov_b32 s60, 1069066811
    s_mov_b32 s61, 1042479491
    v_lshlrev_b32 v144, 16, v196
    v_lshlrev_b32 v146, 16, v192
    v_and_b32 v147, 0xffff0000, v192
    v_mul_f32 v144, s60, v144
    v_mul_f32 v146, s60, v146
    v_mul_f32 v147, s60, v147
    v_exp_f32 v144, v144
    v_exp_f32 v146, v146
    v_exp_f32 v147, v147
    v_lshlrev_b32 v148, 16, v193
    v_and_b32 v149, 0xffff0000, v193
    v_cvt_pk_bf16_f32 v144, v144, v144
    v_cvt_pk_bf16_f32 v150, v146, v147
    v_and_b32 v144, 0xffff0000, v144
    v_lshlrev_b32 v146, 16, v150
    v_and_b32 v147, 0xffff0000, v150
    v_pk_mul_f32 v[146:147], v[146:147], v[144:145] op_sel_hi:[1,0]
    v_pk_mul_f32 v[148:149], v[148:149], v[144:145] op_sel_hi:[1,0]
    v_pk_mul_f32 v[146:147], v[146:147], s[60:61] op_sel_hi:[1,0]
    v_pk_mul_f32 v[148:149], v[148:149], s[60:61] op_sel:[0,1] op_sel_hi:[1,1]
    v_mul_f32 v150, 0xbf800000, v146
    v_mul_f32 v151, 0x3f800000, v148
    v_exp_f32 v150, v150
    v_fract_f32 v151, v151
    v_cos_f32 v102, v151
    v_sin_f32 v103, v151
    s_nop 0
    v_pk_mul_f32 v[102:103], v[102:103], v[150:151] op_sel_hi:[1,0]
    v_mul_f32 v150, 0xbf800000, v147
    v_mul_f32 v151, 0x3f800000, v149
    v_exp_f32 v150, v150
    v_fract_f32 v151, v151
    v_cos_f32 v104, v151
    v_sin_f32 v105, v151
    s_nop 0
    v_pk_mul_f32 v[104:105], v[104:105], v[150:151] op_sel_hi:[1,0]
    v_mul_f32 v150, 0xc3800000, v146
    v_mul_f32 v151, 0x43800000, v148
    v_exp_f32 v150, v150
    v_fract_f32 v151, v151
    v_cos_f32 v106, v151
    v_sin_f32 v107, v151
    s_nop 0
    v_pk_mul_f32 v[106:107], v[106:107], v[150:151] op_sel_hi:[1,0]
    v_mul_f32 v150, 0xc3800000, v147
    v_mul_f32 v151, 0x43800000, v149
    v_exp_f32 v150, v150
    v_fract_f32 v151, v151
    v_cos_f32 v108, v151
    v_sin_f32 v109, v151
    s_nop 0
    v_pk_mul_f32 v[108:109], v[108:109], v[150:151] op_sel_hi:[1,0]
    v_add_f32 v144, v144, v144
    v_lshlrev_b32 v254, 16, v254
    v_lshlrev_b32 v110, 16, v194
    v_and_b32 v112, 0xffff0000, v194
    v_lshlrev_b32 v111, 16, v195
    v_and_b32 v113, 0xffff0000, v195
    v_pk_mul_f32 v[110:111], v[110:111], v[144:145] op_sel_hi:[1,0]
    v_pk_mul_f32 v[112:113], v[112:113], v[144:145] op_sel_hi:[1,0]
    v_cvt_pk_bf16_f32 v136, v110, -v111
    v_cvt_pk_bf16_f32 v137, v112, -v113
    ds_write_b64 v9, v[136:137] offset:16896
    v_pk_mul_f32 v[134:135], v[110:111], v[102:103] op_sel_hi:[1,0]
    v_pk_fma_f32 v[130:131], v[110:111], v[102:103], v[134:135] op_sel:[1,1,0] op_sel_hi:[0,1,1] neg_lo:[1,0,0]
    v_pk_mul_f32 v[134:135], v[112:113], v[104:105] op_sel_hi:[1,0]
    v_pk_fma_f32 v[132:133], v[112:113], v[104:105], v[134:135] op_sel:[1,1,0] op_sel_hi:[0,1,1] neg_lo:[1,0,0]
    v_cvt_pk_bf16_f32 v138, v130, -v131
    v_cvt_pk_bf16_f32 v139, v132, -v133
    ds_write_b64 v9, v[138:139] offset:17424
    v_pk_mul_f32 v[134:135], v[130:131], v[102:103] op_sel_hi:[1,0]
    v_pk_fma_f32 v[114:115], v[130:131], v[102:103], v[134:135] op_sel:[1,1,0] op_sel_hi:[0,1,1] neg_lo:[1,0,0]
    v_pk_mul_f32 v[134:135], v[132:133], v[104:105] op_sel_hi:[1,0]
    v_pk_fma_f32 v[116:117], v[132:133], v[104:105], v[134:135] op_sel:[1,1,0] op_sel_hi:[0,1,1] neg_lo:[1,0,0]
    v_cvt_pk_bf16_f32 v140, v114, -v115
    v_cvt_pk_bf16_f32 v141, v116, -v117
    ds_write_b64 v9, v[140:141] offset:17952
    v_pk_mul_f32 v[134:135], v[114:115], v[102:103] op_sel_hi:[1,0]
    v_pk_fma_f32 v[130:131], v[114:115], v[102:103], v[134:135] op_sel:[1,1,0] op_sel_hi:[0,1,1] neg_lo:[1,0,0]
    v_pk_mul_f32 v[134:135], v[116:117], v[104:105] op_sel_hi:[1,0]
    v_pk_fma_f32 v[132:133], v[116:117], v[104:105], v[134:135] op_sel:[1,1,0] op_sel_hi:[0,1,1] neg_lo:[1,0,0]
    v_cvt_pk_bf16_f32 v142, v130, -v131
    v_cvt_pk_bf16_f32 v143, v132, -v133
    ds_write_b64 v9, v[142:143] offset:18480
    v_pk_mul_f32 v[134:135], v[130:131], v[102:103] op_sel_hi:[1,0]
    v_pk_fma_f32 v[118:119], v[130:131], v[102:103], v[134:135] op_sel:[1,1,0] op_sel_hi:[0,1,1] neg_lo:[1,0,0]
    v_pk_mul_f32 v[134:135], v[132:133], v[104:105] op_sel_hi:[1,0]
    v_pk_fma_f32 v[120:121], v[132:133], v[104:105], v[134:135] op_sel:[1,1,0] op_sel_hi:[0,1,1] neg_lo:[1,0,0]
    v_cvt_pk_bf16_f32 v136, v118, -v119
    v_cvt_pk_bf16_f32 v137, v120, -v121
    ds_write_b64 v9, v[136:137] offset:21120
    v_pk_mul_f32 v[134:135], v[118:119], v[102:103] op_sel_hi:[1,0]
    v_pk_fma_f32 v[130:131], v[118:119], v[102:103], v[134:135] op_sel:[1,1,0] op_sel_hi:[0,1,1] neg_lo:[1,0,0]
    v_pk_mul_f32 v[134:135], v[120:121], v[104:105] op_sel_hi:[1,0]
    v_pk_fma_f32 v[132:133], v[120:121], v[104:105], v[134:135] op_sel:[1,1,0] op_sel_hi:[0,1,1] neg_lo:[1,0,0]
    v_cvt_pk_bf16_f32 v138, v130, -v131
    v_cvt_pk_bf16_f32 v139, v132, -v133
    ds_write_b64 v9, v[138:139] offset:21648
    v_pk_mul_f32 v[134:135], v[130:131], v[102:103] op_sel_hi:[1,0]
    v_pk_fma_f32 v[122:123], v[130:131], v[102:103], v[134:135] op_sel:[1,1,0] op_sel_hi:[0,1,1] neg_lo:[1,0,0]
    v_pk_mul_f32 v[134:135], v[132:133], v[104:105] op_sel_hi:[1,0]
    v_pk_fma_f32 v[124:125], v[132:133], v[104:105], v[134:135] op_sel:[1,1,0] op_sel_hi:[0,1,1] neg_lo:[1,0,0]
    v_cvt_pk_bf16_f32 v140, v122, -v123
    v_cvt_pk_bf16_f32 v141, v124, -v125
    ds_write_b64 v9, v[140:141] offset:22176
    v_pk_mul_f32 v[134:135], v[122:123], v[102:103] op_sel_hi:[1,0]
    v_pk_fma_f32 v[130:131], v[122:123], v[102:103], v[134:135] op_sel:[1,1,0] op_sel_hi:[0,1,1] neg_lo:[1,0,0]
    v_pk_mul_f32 v[134:135], v[124:125], v[104:105] op_sel_hi:[1,0]
    v_pk_fma_f32 v[132:133], v[124:125], v[104:105], v[134:135] op_sel:[1,1,0] op_sel_hi:[0,1,1] neg_lo:[1,0,0]
    v_cvt_pk_bf16_f32 v142, v130, -v131
    v_cvt_pk_bf16_f32 v143, v132, -v133
    ds_write_b64 v9, v[142:143] offset:22704
    v_pk_mul_f32 v[134:135], v[130:131], v[102:103] op_sel_hi:[1,0]
    v_pk_fma_f32 v[126:127], v[130:131], v[102:103], v[134:135] op_sel:[1,1,0] op_sel_hi:[0,1,1] neg_lo:[1,0,0]
    v_pk_mul_f32 v[134:135], v[132:133], v[104:105] op_sel_hi:[1,0]
    v_pk_fma_f32 v[128:129], v[132:133], v[104:105], v[134:135] op_sel:[1,1,0] op_sel_hi:[0,1,1] neg_lo:[1,0,0]
    v_cvt_pk_bf16_f32 v136, v126, -v127
    v_cvt_pk_bf16_f32 v137, v128, -v129
    ds_write_b64 v9, v[136:137] offset:25344
    v_pk_mul_f32 v[134:135], v[110:111], v[106:107] op_sel_hi:[1,0]
    v_pk_fma_f32 v[110:111], v[110:111], v[106:107], v[134:135] op_sel:[1,1,0] op_sel_hi:[0,1,1] neg_lo:[1,0,0]
    v_pk_mul_f32 v[134:135], v[112:113], v[108:109] op_sel_hi:[1,0]
    v_pk_fma_f32 v[112:113], v[112:113], v[108:109], v[134:135] op_sel:[1,1,0] op_sel_hi:[0,1,1] neg_lo:[1,0,0]
    v_cvt_pk_bf16_f32 v138, v110, -v111
    v_cvt_pk_bf16_f32 v139, v112, -v113
    ds_write_b64 v9, v[138:139] offset:19008
    ds_write_b64 v9, v[138:139] offset:19536
    v_pk_mul_f32 v[134:135], v[114:115], v[106:107] op_sel_hi:[1,0]
    v_pk_fma_f32 v[114:115], v[114:115], v[106:107], v[134:135] op_sel:[1,1,0] op_sel_hi:[0,1,1] neg_lo:[1,0,0]
    v_pk_mul_f32 v[134:135], v[116:117], v[108:109] op_sel_hi:[1,0]
    v_pk_fma_f32 v[116:117], v[116:117], v[108:109], v[134:135] op_sel:[1,1,0] op_sel_hi:[0,1,1] neg_lo:[1,0,0]
    v_cvt_pk_bf16_f32 v140, v114, -v115
    v_cvt_pk_bf16_f32 v141, v116, -v117
    ds_write_b64 v9, v[140:141] offset:20064
    v_pk_mul_f32 v[134:135], v[118:119], v[106:107] op_sel_hi:[1,0]
    v_pk_fma_f32 v[118:119], v[118:119], v[106:107], v[134:135] op_sel:[1,1,0] op_sel_hi:[0,1,1] neg_lo:[1,0,0]
    v_pk_mul_f32 v[134:135], v[120:121], v[108:109] op_sel_hi:[1,0]
    v_pk_fma_f32 v[120:121], v[120:121], v[108:109], v[134:135] op_sel:[1,1,0] op_sel_hi:[0,1,1] neg_lo:[1,0,0]
    v_cvt_pk_bf16_f32 v142, v118, -v119
    v_cvt_pk_bf16_f32 v143, v120, -v121
    ds_write_b64 v9, v[142:143] offset:20592
    ds_write_b64 v9, v[142:143] offset:23232
    ds_write_b64 v9, v[142:143] offset:23760
    v_pk_mul_f32 v[134:135], v[122:123], v[106:107] op_sel_hi:[1,0]
    v_pk_fma_f32 v[122:123], v[122:123], v[106:107], v[134:135] op_sel:[1,1,0] op_sel_hi:[0,1,1] neg_lo:[1,0,0]
    v_pk_mul_f32 v[134:135], v[124:125], v[108:109] op_sel_hi:[1,0]
    v_pk_fma_f32 v[124:125], v[124:125], v[108:109], v[134:135] op_sel:[1,1,0] op_sel_hi:[0,1,1] neg_lo:[1,0,0]
    v_cvt_pk_bf16_f32 v136, v122, -v123
    v_cvt_pk_bf16_f32 v137, v124, -v125
    ds_write_b64 v9, v[136:137] offset:24288
    v_pk_mul_f32 v[134:135], v[126:127], v[106:107] op_sel_hi:[1,0]
    v_pk_fma_f32 v[126:127], v[126:127], v[106:107], v[134:135] op_sel:[1,1,0] op_sel_hi:[0,1,1] neg_lo:[1,0,0]
    v_pk_mul_f32 v[134:135], v[128:129], v[108:109] op_sel_hi:[1,0]
    v_pk_fma_f32 v[128:129], v[128:129], v[108:109], v[134:135] op_sel:[1,1,0] op_sel_hi:[0,1,1] neg_lo:[1,0,0]
    v_cvt_pk_bf16_f32 v138, v126, -v127
    v_cvt_pk_bf16_f32 v139, v128, -v129
    ds_write_b64 v9, v[138:139] offset:24816
    ds_write_b64 v9, v[138:139] offset:27456
    v_pk_mul_f32 v[134:135], v[118:119], v[106:107] op_sel_hi:[1,0]
    v_pk_fma_f32 v[118:119], v[118:119], v[106:107], v[134:135] op_sel:[1,1,0] op_sel_hi:[0,1,1] neg_lo:[1,0,0]
    v_pk_mul_f32 v[134:135], v[120:121], v[108:109] op_sel_hi:[1,0]
    v_pk_fma_f32 v[120:121], v[120:121], v[108:109], v[134:135] op_sel:[1,1,0] op_sel_hi:[0,1,1] neg_lo:[1,0,0]
    v_cvt_pk_bf16_f32 v140, v118, -v119
    v_cvt_pk_bf16_f32 v141, v120, -v121
    ds_write_b64 v9, v[140:141] offset:25872
    v_pk_mul_f32 v[134:135], v[126:127], v[106:107] op_sel_hi:[1,0]
    v_pk_fma_f32 v[126:127], v[126:127], v[106:107], v[134:135] op_sel:[1,1,0] op_sel_hi:[0,1,1] neg_lo:[1,0,0]
    v_pk_mul_f32 v[134:135], v[128:129], v[108:109] op_sel_hi:[1,0]
    v_pk_fma_f32 v[128:129], v[128:129], v[108:109], v[134:135] op_sel:[1,1,0] op_sel_hi:[0,1,1] neg_lo:[1,0,0]
    v_cvt_pk_bf16_f32 v142, v126, -v127
    v_cvt_pk_bf16_f32 v143, v128, -v129
    ds_write_b64 v9, v[142:143] offset:26400
    v_pk_mul_f32 v[134:135], v[118:119], v[106:107] op_sel_hi:[1,0]
    v_pk_fma_f32 v[118:119], v[118:119], v[106:107], v[134:135] op_sel:[1,1,0] op_sel_hi:[0,1,1] neg_lo:[1,0,0]
    v_pk_mul_f32 v[134:135], v[120:121], v[108:109] op_sel_hi:[1,0]
    v_pk_fma_f32 v[120:121], v[120:121], v[108:109], v[134:135] op_sel:[1,1,0] op_sel_hi:[0,1,1] neg_lo:[1,0,0]
    v_cvt_pk_bf16_f32 v136, v118, -v119
    v_cvt_pk_bf16_f32 v137, v120, -v121
    ds_write_b64 v9, v[136:137] offset:27984
    v_pk_mul_f32 v[134:135], v[126:127], v[106:107] op_sel_hi:[1,0]
    v_pk_fma_f32 v[126:127], v[126:127], v[106:107], v[134:135] op_sel:[1,1,0] op_sel_hi:[0,1,1] neg_lo:[1,0,0]
    v_pk_mul_f32 v[134:135], v[128:129], v[108:109] op_sel_hi:[1,0]
    v_pk_fma_f32 v[128:129], v[128:129], v[108:109], v[134:135] op_sel:[1,1,0] op_sel_hi:[0,1,1] neg_lo:[1,0,0]
    v_cvt_pk_bf16_f32 v138, v126, -v127
    v_cvt_pk_bf16_f32 v139, v128, -v129
    ds_write_b64 v9, v[138:139] offset:28512
    v_pk_mul_f32 v[134:135], v[126:127], v[106:107] op_sel_hi:[1,0]
    v_pk_fma_f32 v[126:127], v[126:127], v[106:107], v[134:135] op_sel:[1,1,0] op_sel_hi:[0,1,1] neg_lo:[1,0,0]
    v_pk_mul_f32 v[134:135], v[128:129], v[108:109] op_sel_hi:[1,0]
    v_pk_fma_f32 v[128:129], v[128:129], v[108:109], v[134:135] op_sel:[1,1,0] op_sel_hi:[0,1,1] neg_lo:[1,0,0]
    v_cvt_pk_bf16_f32 v140, v126, -v127
    v_cvt_pk_bf16_f32 v141, v128, -v129
    ds_write_b64 v9, v[140:141] offset:26928
    v_pk_mul_f32 v[134:135], v[126:127], v[106:107] op_sel_hi:[1,0]
    v_pk_fma_f32 v[126:127], v[126:127], v[106:107], v[134:135] op_sel:[1,1,0] op_sel_hi:[0,1,1] neg_lo:[1,0,0]
    v_pk_mul_f32 v[134:135], v[128:129], v[108:109] op_sel_hi:[1,0]
    v_pk_fma_f32 v[128:129], v[128:129], v[108:109], v[134:135] op_sel:[1,1,0] op_sel_hi:[0,1,1] neg_lo:[1,0,0]
    v_cvt_pk_bf16_f32 v142, v126, -v127
    v_cvt_pk_bf16_f32 v143, v128, -v129
    ds_write_b64 v9, v[142:143] offset:29568
    v_pk_mul_f32 v[134:135], v[126:127], v[106:107] op_sel_hi:[1,0]
    v_pk_fma_f32 v[126:127], v[126:127], v[106:107], v[134:135] op_sel:[1,1,0] op_sel_hi:[0,1,1] neg_lo:[1,0,0]
    v_pk_mul_f32 v[134:135], v[128:129], v[108:109] op_sel_hi:[1,0]
    v_pk_fma_f32 v[128:129], v[128:129], v[108:109], v[134:135] op_sel:[1,1,0] op_sel_hi:[0,1,1] neg_lo:[1,0,0]
    v_cvt_pk_bf16_f32 v136, v126, -v127
    v_cvt_pk_bf16_f32 v137, v128, -v129
    ds_write_b64 v9, v[136:137] offset:29040
    v_pk_mul_f32 v[134:135], v[126:127], v[106:107] op_sel_hi:[1,0]
    v_pk_fma_f32 v[126:127], v[126:127], v[106:107], v[134:135] op_sel:[1,1,0] op_sel_hi:[0,1,1] neg_lo:[1,0,0]
    v_pk_mul_f32 v[134:135], v[128:129], v[108:109] op_sel_hi:[1,0]
    v_pk_fma_f32 v[128:129], v[128:129], v[108:109], v[134:135] op_sel:[1,1,0] op_sel_hi:[0,1,1] neg_lo:[1,0,0]
    v_cvt_pk_bf16_f32 v138, v126, -v127
    v_cvt_pk_bf16_f32 v139, v128, -v129
    ds_write_b64 v9, v[138:139] offset:31680
    ds_read_b128 v[102:105], v242 offset:16896
    ds_read_b128 v[110:113], v242 offset:16928
    ds_read_b128 v[118:121], v242 offset:16960
    ds_read_b128 v[126:129], v242 offset:16992
    ds_read_b128 v[134:137], v242 offset:17024
    ds_read_b128 v[142:145], v242 offset:17056
    ds_read_b128 v[150:153], v242 offset:17088
    ds_read_b128 v[158:161], v242 offset:17120
    ds_read_b128 v[166:169], v242 offset:17152
    ds_read_b128 v[174:177], v242 offset:17184
    ds_read_b128 v[182:185], v242 offset:17216
    ds_read_b128 v[190:193], v242 offset:17248
    ds_read_b128 v[198:201], v242 offset:17280
    ds_read_b128 v[206:209], v242 offset:17312
    ds_read_b128 v[214:217], v242 offset:17344
    ds_read_b128 v[222:225], v242 offset:17376
    ds_write_b128 v248, v[16:19]
    ds_write_b128 v249, v[16:19]
    v_mov_b32 v9, 150432
    s_mov_b32 s61, 0
Lfw36:
    ds_read_b128 v[20:23], v9 offset:240
    s_add_u32 s61, s61, 1
    s_waitcnt lgkmcnt(0)
    v_min3_u32 v20, v20, v21, v22
    v_min_u32 v20, v20, v23
    v_cmp_eq_u32 vcc, 0, v20
    s_cmp_ge_u32 s61, 4194304
    s_cbranch_scc1 Lfd37
    s_cbranch_vccnz Lfw36
Lfd37:
    ds_read_b128 v[46:49], v251 offset:0
    ds_read_b128 v[50:53], v251 offset:1024
    ds_read_b128 v[54:57], v251 offset:2048
    ds_read_b128 v[62:65], v251 offset:3072
    ds_read_b128 v[66:69], v251 offset:4096
    ds_read_b128 v[230:233], v251 offset:5120
    ds_read_b128 v[234:237], v251 offset:6144
    ds_read_b128 v[238:241], v251 offset:7168
    s_mov_b32 s61, 0
Lfw38:
    ds_read_b32 v20, v8 offset:192
    s_add_u32 s61, s61, 1
    s_waitcnt lgkmcnt(0)
    v_cmp_eq_u32 vcc, 0, v20
    s_cmp_ge_u32 s61, 4194304
    s_cbranch_scc1 Lfd39
    s_cbranch_vccnz Lfw38
Lfd39:
    ds_read_b128 v[106:109], v242 offset:0
    ds_read_b128 v[114:117], v242 offset:32
    ds_read_b128 v[122:125], v242 offset:64
    ds_read_b128 v[130:133], v242 offset:96
    ds_read_b128 v[138:141], v242 offset:128
    ds_read_b128 v[146:149], v242 offset:160
    ds_read_b128 v[154:157], v242 offset:192
    ds_read_b128 v[162:165], v242 offset:224
    s_waitcnt lgkmcnt(7)
    v_mfma_f32_32x32x16_bf16 v[70:85], v[102:105], v[106:109], 0
    ds_read_b128 v[170:173], v242 offset:256
    s_waitcnt lgkmcnt(7)
    v_mfma_f32_32x32x16_bf16 v[70:85], v[110:113], v[114:117], v[70:85]
    ds_read_b128 v[178:181], v242 offset:288
    s_waitcnt lgkmcnt(7)
    v_mfma_f32_32x32x16_bf16 v[70:85], v[118:121], v[122:125], v[70:85]
    ds_read_b128 v[186:189], v242 offset:320
    s_waitcnt lgkmcnt(7)
    v_mfma_f32_32x32x16_bf16 v[70:85], v[126:129], v[130:133], v[70:85]
    ds_read_b128 v[194:197], v242 offset:352
    s_waitcnt lgkmcnt(7)
    v_mfma_f32_32x32x16_bf16 v[70:85], v[134:137], v[138:141], v[70:85]
    ds_read_b128 v[202:205], v242 offset:384
    s_waitcnt lgkmcnt(7)
    v_mfma_f32_32x32x16_bf16 v[70:85], v[142:145], v[146:149], v[70:85]
    ds_read_b128 v[210:213], v242 offset:416
    s_waitcnt lgkmcnt(7)
    v_mfma_f32_32x32x16_bf16 v[70:85], v[150:153], v[154:157], v[70:85]
    ds_read_b128 v[218:221], v242 offset:448
    s_waitcnt lgkmcnt(7)
    v_mfma_f32_32x32x16_bf16 v[70:85], v[158:161], v[162:165], v[70:85]
    ds_read_b128 v[226:229], v242 offset:480
    s_waitcnt lgkmcnt(7)
    v_mfma_f32_32x32x16_bf16 v[70:85], v[166:169], v[170:173], v[70:85]
    s_waitcnt lgkmcnt(6)
    v_mfma_f32_32x32x16_bf16 v[70:85], v[174:177], v[178:181], v[70:85]
    s_waitcnt lgkmcnt(5)
    v_mfma_f32_32x32x16_bf16 v[70:85], v[182:185], v[186:189], v[70:85]
    s_waitcnt lgkmcnt(4)
    v_mfma_f32_32x32x16_bf16 v[70:85], v[190:193], v[194:197], v[70:85]
    s_waitcnt lgkmcnt(3)
    v_mfma_f32_32x32x16_bf16 v[70:85], v[198:201], v[202:205], v[70:85]
    s_waitcnt lgkmcnt(2)
    v_mfma_f32_32x32x16_bf16 v[70:85], v[206:209], v[210:213], v[70:85]
    s_waitcnt lgkmcnt(1)
    v_mfma_f32_32x32x16_bf16 v[70:85], v[214:217], v[218:221], v[70:85]
    s_waitcnt lgkmcnt(0)
    v_mfma_f32_32x32x16_bf16 v[70:85], v[222:225], v[226:229], v[70:85]
    s_nop 11
    v_cvt_pk_bf16_f32 v86, v77, v76
    v_cvt_pk_bf16_f32 v87, v75, v74
    v_cvt_pk_bf16_f32 v88, v73, v72
    v_cvt_pk_bf16_f32 v89, v71, v70
    ds_write_b128 v243, v[86:89] offset:0
    ds_write2_b32 v244, v86, v87 offset0:0 offset1:1
    ds_write2_b32 v244, v88, v89 offset0:2 offset1:3
    v_cvt_pk_bf16_f32 v90, v78, v77
    v_cvt_pk_bf16_f32 v91, v76, v75
    v_cvt_pk_bf16_f32 v92, v74, v73
    v_cvt_pk_bf16_f32 v93, v72, v71
    ds_write_b128 v243, v[90:93] offset:1344
    ds_write2_b32 v245, v90, v91 offset0:0 offset1:1
    ds_write2_b32 v245, v92, v93 offset0:2 offset1:3
    ds_read_b64 v[142:143], v2 offset:1024
    ds_read_b64 v[144:145], v2 offset:1032
    ds_read_b64 v[206:207], v2 offset:0
    ds_read_b64 v[208:209], v2 offset:8
    ds_write2_b32 v246, v79, v80 offset0:0 offset1:1
    ds_write_b32 v247, v81
    ds_write_b32 v247, v82 offset:128
    v_cvt_pk_bf16_f32 v255, v254, v254
    v_cvt_pk_bf16_f32 v94, v70, v70
    v_cvt_pk_bf16_f32 v95, v78, v78
    v_cvt_pk_bf16_f32 v96, v80, v80
    ds_read_b64 v[174:175], v2 offset:512
    ds_read_b64 v[176:177], v2 offset:520
    v_readlane_b32 s60, v94, 0
    v_readlane_b32 s61, v95, 63
    v_readlane_b32 s62, v96, 63
    ds_read_b64 v[146:147], v2 offset:960
    ds_read_b64 v[148:149], v2 offset:968
    ds_read_b64 v[178:179], v2 offset:448
    ds_read_b64 v[180:181], v2 offset:456
    ds_read_b64 v[150:151], v2 offset:896
    ds_read_b64 v[152:153], v2 offset:904
    ds_read_b64 v[182:183], v2 offset:384
    ds_read_b64 v[184:185], v2 offset:392
    ds_read_b64 v[154:155], v2 offset:832
    ds_read_b64 v[156:157], v2 offset:840
    ds_read_b64 v[186:187], v2 offset:320
    ds_read_b64 v[188:189], v2 offset:328
    s_waitcnt lgkmcnt(14)
    v_bfi_b32 v142, v230, s60, v142
    v_bfi_b32 v206, v234, s61, v206
    v_and_b32 v210, s62, v238
    v_and_b32 v58, v255, v230
    v_bfi_b32 v143, v231, s60, v143
    v_bfi_b32 v207, v235, s61, v207
    v_and_b32 v211, s62, v239
    v_and_b32 v59, v255, v231
    v_bfi_b32 v144, v232, s60, v144
    v_bfi_b32 v208, v236, s61, v208
    v_and_b32 v212, s62, v240
    v_and_b32 v60, v255, v232
    v_bfi_b32 v145, v233, s60, v145
    v_bfi_b32 v209, v237, s61, v209
    v_and_b32 v213, s62, v241
    v_and_b32 v61, v255, v233
    ds_read_b64 v[158:159], v2 offset:768
    ds_read_b64 v[160:161], v2 offset:776
    ds_read_b64 v[190:191], v2 offset:256
    ds_read_b64 v[192:193], v2 offset:264
    ds_read_b64 v[162:163], v2 offset:704
    ds_read_b64 v[164:165], v2 offset:712
    ds_read_b64 v[194:195], v2 offset:192
    ds_read_b64 v[196:197], v2 offset:200
    ds_read_b64 v[166:167], v2 offset:640
    ds_read_b64 v[168:169], v2 offset:648
    ds_read_b64 v[198:199], v2 offset:128
    ds_read_b64 v[200:201], v2 offset:136
    ds_read_b64 v[170:171], v2 offset:576
    ds_read_b64 v[172:173], v2 offset:584
    ds_read_b64 v[202:203], v2 offset:64
    ds_read_b64 v[204:205], v2 offset:72
    ds_read_b128 v[214:217], v3 offset:256
    ds_read_b128 v[218:221], v3 offset:240
    ds_read_b128 v[222:225], v3 offset:224
    ds_read_b128 v[226:229], v3 offset:208
    ds_read_b128 v[230:233], v3 offset:512
    ds_read_b128 v[234:237], v3 offset:496
    ds_read_b128 v[238:241], v3 offset:480
    ds_read_b128 v[242:245], v3 offset:464
    ds_read_b128 v[86:89], v3 offset:768
    ds_read_b128 v[90:93], v3 offset:752
    ds_read_b128 v[94:97], v3 offset:736
    ds_read_b128 v[98:101], v3 offset:720
    ds_read2_b64 v[10:13], v4 offset0:16 offset1:15
    ds_read2_b64 v[14:17], v4 offset0:14 offset1:13
    ds_read2_b64 v[18:21], v4 offset0:32 offset1:31
    ds_read2_b64 v[22:25], v4 offset0:30 offset1:29
    ds_read2_b64 v[34:37], v4 offset0:48 offset1:47
    ds_read2_b64 v[38:41], v4 offset0:46 offset1:45
    ds_read2_b64 v[246:249], v4 offset0:64 offset1:63
    ds_read2_b64 v[250:253], v4 offset0:62 offset1:61
    s_waitcnt lgkmcnt(14)
    v_cvt_pk_bf16_f32 v102, v214, v218
    v_cvt_pk_bf16_f32 v103, v222, v226
    v_cvt_pk_bf16_f32 v104, v215, v219
    v_cvt_pk_bf16_f32 v105, v223, v227
    v_cvt_pk_bf16_f32 v106, v216, v220
    v_cvt_pk_bf16_f32 v107, v224, v228
    v_cvt_pk_bf16_f32 v108, v217, v221
    v_cvt_pk_bf16_f32 v109, v225, v229
    s_waitcnt lgkmcnt(12)
    v_cvt_pk_bf16_f32 v110, v230, v234
    v_cvt_pk_bf16_f32 v111, v238, v242
    v_cvt_pk_bf16_f32 v112, v231, v235
    v_cvt_pk_bf16_f32 v113, v239, v243
    v_cvt_pk_bf16_f32 v114, v232, v236
    v_cvt_pk_bf16_f32 v115, v240, v244
    v_cvt_pk_bf16_f32 v116, v233, v237
    v_cvt_pk_bf16_f32 v117, v241, v245
    s_waitcnt lgkmcnt(8)
    v_cvt_pk_bf16_f32 v118, v86, v90
    v_cvt_pk_bf16_f32 v119, v94, v98
    v_cvt_pk_bf16_f32 v120, v87, v91
    v_cvt_pk_bf16_f32 v121, v95, v99
    v_cvt_pk_bf16_f32 v122, v88, v92
    v_cvt_pk_bf16_f32 v123, v96, v100
    v_cvt_pk_bf16_f32 v124, v89, v93
    v_cvt_pk_bf16_f32 v125, v97, v101
    s_waitcnt lgkmcnt(6)
    v_cvt_pk_bf16_f32 v126, v10, v12
    v_cvt_pk_bf16_f32 v127, v14, v16
    v_cvt_pk_bf16_f32 v128, v11, v13
    v_cvt_pk_bf16_f32 v129, v15, v17
    s_waitcnt lgkmcnt(4)
    v_cvt_pk_bf16_f32 v130, v18, v20
    v_cvt_pk_bf16_f32 v131, v22, v24
    v_cvt_pk_bf16_f32 v132, v19, v21
    v_cvt_pk_bf16_f32 v133, v23, v25
    s_waitcnt lgkmcnt(2)
    v_cvt_pk_bf16_f32 v134, v34, v36
    v_cvt_pk_bf16_f32 v135, v38, v40
    v_cvt_pk_bf16_f32 v136, v35, v37
    v_cvt_pk_bf16_f32 v137, v39, v41
    s_waitcnt lgkmcnt(0)
    v_cvt_pk_bf16_f32 v138, v246, v248
    v_cvt_pk_bf16_f32 v139, v250, v252
    v_cvt_pk_bf16_f32 v140, v247, v249
    v_cvt_pk_bf16_f32 v141, v251, v253
    s_mov_b32 s61, 0
Lfw40:
    ds_read_b32 v34, v9 offset:0
    s_add_u32 s61, s61, 1
    s_waitcnt lgkmcnt(0)
    v_cmp_eq_u32 vcc, 0, v34
    s_cmp_ge_u32 s61, 4194304
    s_cbranch_scc1 Lfd41
    s_cbranch_vccnz Lfw40
Lfd41:
    ds_read_b128 v[10:13], v6 offset:448
    ds_read_b128 v[14:17], v6 offset:384
    ds_read_b128 v[18:21], v6 offset:320
    ds_read_b128 v[22:25], v6 offset:256
    ds_read_b128 v[26:29], v6 offset:192
    s_waitcnt lgkmcnt(4)
    v_mfma_f32_16x16x32_bf16 v[34:37], v[10:13], v[46:49], 0
    ds_read_b128 v[30:33], v6 offset:432
    v_mfma_f32_16x16x32_bf16 v[38:41], v[10:13], v[50:53], 0
    v_mfma_f32_16x16x32_bf16 v[42:45], v[10:13], v[54:57], 0
    v_mfma_f32_16x16x32_bf16 v[2:5], v[10:13], v[62:65], 0
    v_mfma_f32_16x16x32_bf16 v[70:73], v[142:145], v[10:13], 0
    v_mfma_f32_16x16x32_bf16 v[74:77], v[174:177], v[10:13], 0
    v_mfma_f32_16x16x32_bf16 v[70:73], v[58:61], v[10:13], v[70:73]
    v_mfma_f32_16x16x32_bf16 v[78:81], v[206:209], v[10:13], 0
    v_cvt_pk_bf16_f32 v230, v34, v35
    v_cvt_pk_bf16_f32 v231, v36, v37
    v_mfma_f32_16x16x32_bf16 v[86:89], v[210:213], v[10:13], 0
    s_waitcnt lgkmcnt(3)
    v_cvt_pk_bf16_f32 v232, v38, v39
    v_mfma_f32_16x16x32_bf16 v[70:73], v[146:149], v[14:17], v[70:73]
    ds_read_b32 v254, v9 offset:4
    ds_read_b128 v[10:13], v6 offset:128
    v_mfma_f32_16x16x32_bf16 v[74:77], v[178:181], v[14:17], v[74:77]
    v_cvt_pk_bf16_f32 v233, v40, v41
    v_cvt_pk_bf16_f32 v234, v42, v43
    v_mfma_f32_16x16x32_bf16 v[70:73], v[150:153], v[18:21], v[70:73]
    ds_read_b128 v[14:17], v6 offset:64
    v_cvt_pk_bf16_f32 v235, v44, v45
    v_mfma_f32_16x16x32_bf16 v[74:77], v[182:185], v[18:21], v[74:77]
    s_waitcnt lgkmcnt(4)
    v_cvt_pk_bf16_f32 v214, v2, v3
    v_mfma_f32_16x16x32_bf16 v[70:73], v[154:157], v[22:25], v[70:73]
    s_waitcnt lgkmcnt(2)
    ds_read_b128 v[18:21], v6 offset:0
    v_mfma_f32_16x16x32_bf16 v[74:77], v[186:189], v[22:25], v[74:77]
    v_cvt_pk_bf16_f32 v215, v4, v5
    v_cmp_eq_u32 vcc, 0, v254
    v_mfma_f32_16x16x32_bf16 v[70:73], v[158:161], v[26:29], v[70:73]
    s_cbranch_vccnz LMw1
LMb1:
    ds_read_b128 v[22:25], v6 offset:960
    v_mfma_f32_16x16x32_bf16 v[74:77], v[190:193], v[26:29], v[74:77]
    v_mfma_f32_16x16x32_bf16 v[34:37], v[30:33], v[50:53], 0
    ds_read_b128 v[26:29], v6 offset:896
    v_mfma_f32_16x16x32_bf16 v[38:41], v[30:33], v[66:69], 0
    s_waitcnt lgkmcnt(3)
    v_mfma_f32_16x16x32_bf16 v[70:73], v[162:165], v[10:13], v[70:73]
    ds_read_b128 v[30:33], v6 offset:832
    v_mfma_f32_16x16x32_bf16 v[74:77], v[194:197], v[10:13], v[74:77]
    v_mfma_f32_16x16x32_bf16 v[70:73], v[166:169], v[14:17], v[70:73]
    ds_read_b128 v[10:13], v6 offset:768
    v_cvt_pk_bf16_f32 v236, v34, v35
    v_mfma_f32_16x16x32_bf16 v[74:77], v[198:201], v[14:17], v[74:77]
    s_waitcnt lgkmcnt(3)
    v_cvt_pk_bf16_f32 v237, v36, v37
    v_mfma_f32_16x16x32_bf16 v[70:73], v[170:173], v[18:21], v[70:73]
    ds_read_b128 v[14:17], v6 offset:704
    v_cvt_pk_bf16_f32 v216, v38, v39
    v_mfma_f32_16x16x32_bf16 v[74:77], v[202:205], v[18:21], v[74:77]
    v_cvt_pk_bf16_f32 v217, v40, v41
    v_mfma_f32_16x16x32_bf16 v[34:37], v[22:25], v[46:49], 0
    ds_read_b128 v[18:21], v6 offset:944
    v_mfma_f32_16x16x32_bf16 v[38:41], v[22:25], v[50:53], 0
    v_mfma_f32_16x16x32_bf16 v[42:45], v[22:25], v[54:57], 0
    v_mfma_f32_16x16x32_bf16 v[2:5], v[22:25], v[62:65], 0
    v_mfma_f32_16x16x32_bf16 v[74:77], v[142:145], v[22:25], v[74:77]
    ds_write_b128 v7, v[70:73] offset:0
    v_mfma_f32_16x16x32_bf16 v[78:81], v[174:177], v[22:25], v[78:81]
    ds_write_b32 v8, v8 offset:32
    v_mfma_f32_16x16x32_bf16 v[74:77], v[58:61], v[22:25], v[74:77]
    v_cvt_pk_bf16_f32 v238, v34, v35
    v_cvt_pk_bf16_f32 v239, v36, v37
    v_mfma_f32_16x16x32_bf16 v[82:85], v[206:209], v[22:25], 0
    v_cvt_pk_bf16_f32 v240, v38, v39
    v_cvt_pk_bf16_f32 v241, v40, v41
    v_mfma_f32_16x16x32_bf16 v[90:93], v[210:213], v[22:25], 0
    s_waitcnt lgkmcnt(5)
    v_cvt_pk_bf16_f32 v242, v42, v43
    v_mfma_f32_16x16x32_bf16 v[74:77], v[146:149], v[26:29], v[74:77]
    ds_read2_b32 v[254:255], v9 offset0:2 offset1:3
    ds_read_b128 v[22:25], v6 offset:640
    v_mfma_f32_16x16x32_bf16 v[78:81], v[178:181], v[26:29], v[78:81]
    v_cvt_pk_bf16_f32 v243, v44, v45
    v_cvt_pk_bf16_f32 v218, v2, v3
    v_mfma_f32_16x16x32_bf16 v[74:77], v[150:153], v[30:33], v[74:77]
    ds_read_b128 v[26:29], v6 offset:576
    v_cvt_pk_bf16_f32 v219, v4, v5
    v_mfma_f32_16x16x32_bf16 v[78:81], v[182:185], v[30:33], v[78:81]
    s_waitcnt lgkmcnt(6)
    v_mfma_f32_16x16x32_bf16 v[74:77], v[154:157], v[10:13], v[74:77]
    s_waitcnt lgkmcnt(2)
    ds_read_b128 v[30:33], v6 offset:512
    v_mfma_f32_16x16x32_bf16 v[78:81], v[186:189], v[10:13], v[78:81]
    v_min_u32 v254, v254, v255
    v_cmp_eq_u32 vcc, 0, v254
    v_mfma_f32_16x16x32_bf16 v[74:77], v[158:161], v[14:17], v[74:77]
    s_cbranch_vccnz LMw2
LMb2:
    ds_read_b128 v[10:13], v6 offset:1472
    v_mfma_f32_16x16x32_bf16 v[78:81], v[190:193], v[14:17], v[78:81]
    v_mfma_f32_16x16x32_bf16 v[34:37], v[18:21], v[50:53], 0
    ds_read_b128 v[14:17], v6 offset:1408
    v_mfma_f32_16x16x32_bf16 v[38:41], v[18:21], v[66:69], 0
    s_waitcnt lgkmcnt(3)
    v_mfma_f32_16x16x32_bf16 v[74:77], v[162:165], v[22:25], v[74:77]
    ds_read_b128 v[18:21], v6 offset:1344
    v_mfma_f32_16x16x32_bf16 v[78:81], v[194:197], v[22:25], v[78:81]
    v_mfma_f32_16x16x32_bf16 v[74:77], v[166:169], v[26:29], v[74:77]
    ds_read_b128 v[22:25], v6 offset:1280
    v_cvt_pk_bf16_f32 v244, v34, v35
    v_mfma_f32_16x16x32_bf16 v[78:81], v[198:201], v[26:29], v[78:81]
    s_waitcnt lgkmcnt(3)
    v_cvt_pk_bf16_f32 v245, v36, v37
    v_mfma_f32_16x16x32_bf16 v[74:77], v[170:173], v[30:33], v[74:77]
    ds_read_b128 v[26:29], v6 offset:1216
    v_cvt_pk_bf16_f32 v220, v38, v39
    v_mfma_f32_16x16x32_bf16 v[78:81], v[202:205], v[30:33], v[78:81]
    v_cvt_pk_bf16_f32 v221, v40, v41
    v_mfma_f32_16x16x32_bf16 v[34:37], v[10:13], v[46:49], 0
    ds_read_b128 v[30:33], v6 offset:1456
    v_mfma_f32_16x16x32_bf16 v[38:41], v[10:13], v[50:53], 0
    v_mfma_f32_16x16x32_bf16 v[42:45], v[10:13], v[54:57], 0
    v_mfma_f32_16x16x32_bf16 v[2:5], v[10:13], v[62:65], 0
    v_mfma_f32_16x16x32_bf16 v[78:81], v[142:145], v[10:13], v[78:81]
    ds_write_b128 v7, v[74:77] offset:1024
    v_mfma_f32_16x16x32_bf16 v[82:85], v[174:177], v[10:13], v[82:85]
    ds_write_b32 v8, v8 offset:48
    v_mfma_f32_16x16x32_bf16 v[78:81], v[58:61], v[10:13], v[78:81]
    v_cvt_pk_bf16_f32 v246, v34, v35
    v_cvt_pk_bf16_f32 v247, v36, v37
    v_mfma_f32_16x16x32_bf16 v[86:89], v[206:209], v[10:13], v[86:89]
    v_cvt_pk_bf16_f32 v248, v38, v39
    v_cvt_pk_bf16_f32 v249, v40, v41
    v_mfma_f32_16x16x32_bf16 v[94:97], v[210:213], v[10:13], 0
    s_waitcnt lgkmcnt(5)
    v_cvt_pk_bf16_f32 v250, v42, v43
    v_mfma_f32_16x16x32_bf16 v[78:81], v[146:149], v[14:17], v[78:81]
    ds_read_b128 v[10:13], v6 offset:1152
    v_cvt_pk_bf16_f32 v251, v44, v45
    v_mfma_f32_16x16x32_bf16 v[82:85], v[178:181], v[14:17], v[82:85]
    v_cvt_pk_bf16_f32 v222, v2, v3
    v_cvt_pk_bf16_f32 v223, v4, v5
    v_mfma_f32_16x16x32_bf16 v[78:81], v[230:233], v[102:105], v[78:81]
    v_mfma_f32_16x16x32_bf16 v[78:81], v[150:153], v[18:21], v[78:81]
    ds_read_b128 v[14:17], v6 offset:1088
    v_mfma_f32_16x16x32_bf16 v[82:85], v[182:185], v[18:21], v[82:85]
    v_mfma_f32_16x16x32_bf16 v[78:81], v[234:237], v[106:109], v[78:81]
    s_waitcnt lgkmcnt(5)
    v_mfma_f32_16x16x32_bf16 v[78:81], v[154:157], v[22:25], v[78:81]
    ds_read_b128 v[18:21], v6 offset:1024
    v_mfma_f32_16x16x32_bf16 v[82:85], v[186:189], v[22:25], v[82:85]
    v_mfma_f32_16x16x32_bf16 v[78:81], v[158:161], v[26:29], v[78:81]
    ds_read_b128 v[22:25], v6 offset:1984
    v_mfma_f32_16x16x32_bf16 v[82:85], v[190:193], v[26:29], v[82:85]
    s_waitcnt lgkmcnt(3)
    v_mfma_f32_16x16x32_bf16 v[34:37], v[30:33], v[50:53], 0
    ds_read_b128 v[26:29], v6 offset:1920
    v_mfma_f32_16x16x32_bf16 v[38:41], v[30:33], v[66:69], 0
    v_mfma_f32_16x16x32_bf16 v[78:81], v[162:165], v[10:13], v[78:81]
    ds_read_b128 v[30:33], v6 offset:1856
    v_mfma_f32_16x16x32_bf16 v[82:85], v[194:197], v[10:13], v[82:85]
    s_waitcnt lgkmcnt(3)
    v_mfma_f32_16x16x32_bf16 v[78:81], v[166:169], v[14:17], v[78:81]
    ds_read_b128 v[10:13], v6 offset:1792
    v_cvt_pk_bf16_f32 v252, v34, v35
    v_mfma_f32_16x16x32_bf16 v[82:85], v[198:201], v[14:17], v[82:85]
    v_cvt_pk_bf16_f32 v253, v36, v37
    v_cvt_pk_bf16_f32 v224, v38, v39
    v_mfma_f32_16x16x32_bf16 v[78:81], v[170:173], v[18:21], v[78:81]
    ds_read_b128 v[14:17], v6 offset:1728
    v_cvt_pk_bf16_f32 v225, v40, v41
    v_mfma_f32_16x16x32_bf16 v[82:85], v[202:205], v[18:21], v[82:85]
    s_waitcnt lgkmcnt(3)
    v_mfma_f32_16x16x32_bf16 v[34:37], v[22:25], v[46:49], 0
    ds_read_b128 v[18:21], v6 offset:1968
    v_mfma_f32_16x16x32_bf16 v[38:41], v[22:25], v[50:53], 0
    v_mfma_f32_16x16x32_bf16 v[42:45], v[22:25], v[54:57], 0
    v_mfma_f32_16x16x32_bf16 v[2:5], v[22:25], v[62:65], 0
    v_mfma_f32_16x16x32_bf16 v[82:85], v[142:145], v[22:25], v[82:85]
    ds_write_b128 v7, v[78:81] offset:2048
    v_mfma_f32_16x16x32_bf16 v[86:89], v[174:177], v[22:25], v[86:89]
    ds_write_b32 v8, v8 offset:64
    v_mfma_f32_16x16x32_bf16 v[82:85], v[58:61], v[22:25], v[82:85]
    v_cvt_pk_bf16_f32 v70, v34, v35
    v_cvt_pk_bf16_f32 v71, v36, v37
    v_mfma_f32_16x16x32_bf16 v[90:93], v[206:209], v[22:25], v[90:93]
    v_cvt_pk_bf16_f32 v72, v38, v39
    v_cvt_pk_bf16_f32 v73, v40, v41
    v_mfma_f32_16x16x32_bf16 v[98:101], v[210:213], v[22:25], 0
    v_cvt_pk_bf16_f32 v74, v42, v43
    v_cvt_pk_bf16_f32 v75, v44, v45
    v_mfma_f32_16x16x32_bf16 v[82:85], v[146:149], v[26:29], v[82:85]
    ds_read2_b32 v[254:255], v9 offset0:4 offset1:5
    ds_read_b128 v[22:25], v6 offset:1664
    v_mfma_f32_16x16x32_bf16 v[86:89], v[178:181], v[26:29], v[86:89]
    v_cvt_pk_bf16_f32 v226, v2, v3
    v_cvt_pk_bf16_f32 v227, v4, v5
    v_mfma_f32_16x16x32_bf16 v[82:85], v[230:233], v[110:113], v[82:85]
    s_waitcnt lgkmcnt(6)
    v_mfma_f32_16x16x32_bf16 v[82:85], v[150:153], v[30:33], v[82:85]
    ds_read_b128 v[26:29], v6 offset:1600
    v_mfma_f32_16x16x32_bf16 v[86:89], v[182:185], v[30:33], v[86:89]
    v_mfma_f32_16x16x32_bf16 v[82:85], v[234:237], v[114:117], v[82:85]
    v_mfma_f32_16x16x32_bf16 v[82:85], v[154:157], v[10:13], v[82:85]
    s_waitcnt lgkmcnt(2)
    ds_read_b128 v[30:33], v6 offset:1536
    v_mfma_f32_16x16x32_bf16 v[86:89], v[186:189], v[10:13], v[86:89]
    v_min_u32 v254, v254, v255
    v_cmp_eq_u32 vcc, 0, v254
    v_mfma_f32_16x16x32_bf16 v[82:85], v[238:241], v[102:105], v[82:85]
    v_mfma_f32_16x16x32_bf16 v[82:85], v[158:161], v[14:17], v[82:85]
    s_cbranch_vccnz LMw4
LMb4:
    ds_read_b128 v[10:13], v6 offset:2496
    v_mfma_f32_16x16x32_bf16 v[86:89], v[190:193], v[14:17], v[86:89]
    v_mfma_f32_16x16x32_bf16 v[82:85], v[242:245], v[106:109], v[82:85]
    v_mfma_f32_16x16x32_bf16 v[34:37], v[18:21], v[50:53], 0
    ds_read_b128 v[14:17], v6 offset:2432
    v_mfma_f32_16x16x32_bf16 v[38:41], v[18:21], v[66:69], 0
    s_waitcnt lgkmcnt(3)
    v_mfma_f32_16x16x32_bf16 v[82:85], v[162:165], v[22:25], v[82:85]
    ds_read_b128 v[18:21], v6 offset:2368
    v_mfma_f32_16x16x32_bf16 v[86:89], v[194:197], v[22:25], v[86:89]
    v_mfma_f32_16x16x32_bf16 v[82:85], v[166:169], v[26:29], v[82:85]
    ds_read_b128 v[22:25], v6 offset:2304
    v_cvt_pk_bf16_f32 v76, v34, v35
    v_mfma_f32_16x16x32_bf16 v[86:89], v[198:201], v[26:29], v[86:89]
    s_waitcnt lgkmcnt(3)
    v_cvt_pk_bf16_f32 v77, v36, v37
    v_mfma_f32_16x16x32_bf16 v[82:85], v[170:173], v[30:33], v[82:85]
    ds_read_b128 v[26:29], v6 offset:2240
    v_cvt_pk_bf16_f32 v228, v38, v39
    v_mfma_f32_16x16x32_bf16 v[86:89], v[202:205], v[30:33], v[86:89]
    v_cvt_pk_bf16_f32 v229, v40, v41
    v_mfma_f32_16x16x32_bf16 v[34:37], v[10:13], v[46:49], 0
    ds_read_b128 v[30:33], v6 offset:2480
    v_mfma_f32_16x16x32_bf16 v[38:41], v[10:13], v[50:53], 0
    v_mfma_f32_16x16x32_bf16 v[42:45], v[10:13], v[54:57], 0
    v_mfma_f32_16x16x32_bf16 v[86:89], v[142:145], v[10:13], v[86:89]
    v_mfma_f32_16x16x32_bf16 v[90:93], v[174:177], v[10:13], v[90:93]
    ds_write_b128 v7, v[82:85] offset:3072
    v_mfma_f32_16x16x32_bf16 v[86:89], v[58:61], v[10:13], v[86:89]
    ds_write_b32 v8, v8 offset:80
    v_mfma_f32_16x16x32_bf16 v[94:97], v[206:209], v[10:13], v[94:97]
    s_waitcnt lgkmcnt(5)
    v_cvt_pk_bf16_f32 v78, v34, v35
    v_mfma_f32_16x16x32_bf16 v[86:89], v[146:149], v[14:17], v[86:89]
    ds_read_b128 v[10:13], v6 offset:2176
    v_cvt_pk_bf16_f32 v79, v36, v37
    v_mfma_f32_16x16x32_bf16 v[90:93], v[178:181], v[14:17], v[90:93]
    v_cvt_pk_bf16_f32 v80, v38, v39
    v_cvt_pk_bf16_f32 v81, v40, v41
    v_mfma_f32_16x16x32_bf16 v[86:89], v[230:233], v[118:121], v[86:89]
    v_cvt_pk_bf16_f32 v82, v42, v43
    v_cvt_pk_bf16_f32 v83, v44, v45
    v_mfma_f32_16x16x32_bf16 v[86:89], v[150:153], v[18:21], v[86:89]
    ds_read_b128 v[14:17], v6 offset:2112
    v_mfma_f32_16x16x32_bf16 v[90:93], v[182:185], v[18:21], v[90:93]
    v_mfma_f32_16x16x32_bf16 v[86:89], v[234:237], v[122:125], v[86:89]
    s_waitcnt lgkmcnt(5)
    v_mfma_f32_16x16x32_bf16 v[86:89], v[154:157], v[22:25], v[86:89]
    ds_read_b128 v[18:21], v6 offset:2048
    v_mfma_f32_16x16x32_bf16 v[90:93], v[186:189], v[22:25], v[90:93]
    v_mfma_f32_16x16x32_bf16 v[86:89], v[238:241], v[110:113], v[86:89]
    v_mfma_f32_16x16x32_bf16 v[86:89], v[158:161], v[26:29], v[86:89]
    ds_read_b128 v[22:25], v6 offset:3008
    v_mfma_f32_16x16x32_bf16 v[90:93], v[190:193], v[26:29], v[90:93]
    v_mfma_f32_16x16x32_bf16 v[86:89], v[242:245], v[114:117], v[86:89]
    s_waitcnt lgkmcnt(3)
    v_mfma_f32_16x16x32_bf16 v[34:37], v[30:33], v[50:53], 0
    ds_read_b128 v[26:29], v6 offset:2944
    v_mfma_f32_16x16x32_bf16 v[86:89], v[162:165], v[10:13], v[86:89]
    ds_read_b128 v[30:33], v6 offset:2880
    v_mfma_f32_16x16x32_bf16 v[90:93], v[194:197], v[10:13], v[90:93]
    v_mfma_f32_16x16x32_bf16 v[86:89], v[246:249], v[102:105], v[86:89]
    s_waitcnt lgkmcnt(3)
    v_mfma_f32_16x16x32_bf16 v[86:89], v[166:169], v[14:17], v[86:89]
    ds_read_b128 v[10:13], v6 offset:2816
    v_cvt_pk_bf16_f32 v84, v34, v35
    v_mfma_f32_16x16x32_bf16 v[90:93], v[198:201], v[14:17], v[90:93]
    v_cvt_pk_bf16_f32 v85, v36, v37
    v_mfma_f32_16x16x32_bf16 v[86:89], v[250:253], v[106:109], v[86:89]
    v_mfma_f32_16x16x32_bf16 v[86:89], v[170:173], v[18:21], v[86:89]
    ds_read_b128 v[14:17], v6 offset:2752
    v_mfma_f32_16x16x32_bf16 v[90:93], v[202:205], v[18:21], v[90:93]
    v_mfma_f32_16x16x32_bf16 v[86:89], v[214:217], v[126:129], v[86:89]
    s_waitcnt lgkmcnt(3)
    v_mfma_f32_16x16x32_bf16 v[34:37], v[22:25], v[46:49], 0
    ds_read_b128 v[18:21], v6 offset:2992
    v_mfma_f32_16x16x32_bf16 v[38:41], v[22:25], v[50:53], 0
    v_mfma_f32_16x16x32_bf16 v[42:45], v[22:25], v[54:57], 0
    v_mfma_f32_16x16x32_bf16 v[90:93], v[142:145], v[22:25], v[90:93]
    v_mfma_f32_16x16x32_bf16 v[94:97], v[174:177], v[22:25], v[94:97]
    s_nop 0
    ds_write_b128 v7, v[86:89] offset:4096
    v_mfma_f32_16x16x32_bf16 v[90:93], v[58:61], v[22:25], v[90:93]
    ds_write_b32 v8, v8 offset:96
    v_mfma_f32_16x16x32_bf16 v[98:101], v[206:209], v[22:25], v[98:101]
    v_cvt_pk_bf16_f32 v230, v34, v35
    v_cvt_pk_bf16_f32 v231, v36, v37
    v_mfma_f32_16x16x32_bf16 v[90:93], v[146:149], v[26:29], v[90:93]
    ds_read2_b32 v[254:255], v9 offset0:6 offset1:7
    ds_read_b128 v[22:25], v6 offset:2688
    v_mfma_f32_16x16x32_bf16 v[94:97], v[178:181], v[26:29], v[94:97]
    v_cvt_pk_bf16_f32 v232, v38, v39
    v_cvt_pk_bf16_f32 v233, v40, v41
    v_mfma_f32_16x16x32_bf16 v[90:93], v[238:241], v[118:121], v[90:93]
    v_cvt_pk_bf16_f32 v234, v42, v43
    v_cvt_pk_bf16_f32 v235, v44, v45
    v_mfma_f32_16x16x32_bf16 v[90:93], v[242:245], v[122:125], v[90:93]
    s_waitcnt lgkmcnt(6)
    v_mfma_f32_16x16x32_bf16 v[90:93], v[150:153], v[30:33], v[90:93]
    ds_read_b128 v[26:29], v6 offset:2624
    v_mfma_f32_16x16x32_bf16 v[94:97], v[182:185], v[30:33], v[94:97]
    v_mfma_f32_16x16x32_bf16 v[90:93], v[246:249], v[110:113], v[90:93]
    v_mfma_f32_16x16x32_bf16 v[90:93], v[154:157], v[10:13], v[90:93]
    s_waitcnt lgkmcnt(2)
    ds_read_b128 v[30:33], v6 offset:2560
    v_mfma_f32_16x16x32_bf16 v[94:97], v[186:189], v[10:13], v[94:97]
    v_min_u32 v254, v254, v255
    v_cmp_eq_u32 vcc, 0, v254
    v_mfma_f32_16x16x32_bf16 v[90:93], v[250:253], v[114:117], v[90:93]
    v_mfma_f32_16x16x32_bf16 v[90:93], v[158:161], v[14:17], v[90:93]
    s_cbranch_vccnz LMw6
LMb6:
    ds_read_b128 v[10:13], v6 offset:3520
    v_mfma_f32_16x16x32_bf16 v[94:97], v[190:193], v[14:17], v[94:97]
    v_mfma_f32_16x16x32_bf16 v[90:93], v[70:73], v[102:105], v[90:93]
    v_mfma_f32_16x16x32_bf16 v[34:37], v[18:21], v[50:53], 0
    ds_read_b128 v[14:17], v6 offset:3456
    s_waitcnt lgkmcnt(3)
    v_mfma_f32_16x16x32_bf16 v[90:93], v[162:165], v[22:25], v[90:93]
    ds_read_b128 v[18:21], v6 offset:3392
    v_mfma_f32_16x16x32_bf16 v[94:97], v[194:197], v[22:25], v[94:97]
    v_mfma_f32_16x16x32_bf16 v[90:93], v[74:77], v[106:109], v[90:93]
    v_mfma_f32_16x16x32_bf16 v[90:93], v[166:169], v[26:29], v[90:93]
    ds_read_b128 v[22:25], v6 offset:3328
    v_cvt_pk_bf16_f32 v236, v34, v35
    v_mfma_f32_16x16x32_bf16 v[94:97], v[198:201], v[26:29], v[94:97]
    v_cvt_pk_bf16_f32 v237, v36, v37
    v_mfma_f32_16x16x32_bf16 v[90:93], v[214:217], v[130:133], v[90:93]
    s_waitcnt lgkmcnt(3)
    v_mfma_f32_16x16x32_bf16 v[90:93], v[170:173], v[30:33], v[90:93]
    ds_read_b128 v[26:29], v6 offset:3264
    v_mfma_f32_16x16x32_bf16 v[94:97], v[202:205], v[30:33], v[94:97]
    v_mfma_f32_16x16x32_bf16 v[90:93], v[218:221], v[126:129], v[90:93]
    v_mfma_f32_16x16x32_bf16 v[94:97], v[142:145], v[10:13], v[94:97]
    ds_read_b128 v[30:33], v6 offset:3200
    v_mfma_f32_16x16x32_bf16 v[98:101], v[174:177], v[10:13], v[98:101]
    v_mfma_f32_16x16x32_bf16 v[94:97], v[58:61], v[10:13], v[94:97]
    v_mfma_f32_16x16x32_bf16 v[94:97], v[246:249], v[118:121], v[94:97]
    v_mfma_f32_16x16x32_bf16 v[94:97], v[250:253], v[122:125], v[94:97]
    s_waitcnt lgkmcnt(3)
    s_nop 0
    ds_write_b128 v7, v[90:93] offset:5120
    v_mfma_f32_16x16x32_bf16 v[94:97], v[146:149], v[14:17], v[94:97]
    ds_read_b128 v[10:13], v6 offset:3136
    ds_write_b32 v8, v8 offset:112
    v_mfma_f32_16x16x32_bf16 v[98:101], v[178:181], v[14:17], v[98:101]
    v_mfma_f32_16x16x32_bf16 v[94:97], v[70:73], v[110:113], v[94:97]
    v_mfma_f32_16x16x32_bf16 v[94:97], v[150:153], v[18:21], v[94:97]
    ds_read_b128 v[14:17], v6 offset:3072
    v_mfma_f32_16x16x32_bf16 v[98:101], v[182:185], v[18:21], v[98:101]
    v_mfma_f32_16x16x32_bf16 v[94:97], v[74:77], v[114:117], v[94:97]
    s_waitcnt lgkmcnt(5)
    v_mfma_f32_16x16x32_bf16 v[94:97], v[154:157], v[22:25], v[94:97]
    ds_read_b128 v[18:21], v6 offset:4032
    v_mfma_f32_16x16x32_bf16 v[98:101], v[186:189], v[22:25], v[98:101]
    v_mfma_f32_16x16x32_bf16 v[94:97], v[78:81], v[102:105], v[94:97]
    v_mfma_f32_16x16x32_bf16 v[94:97], v[158:161], v[26:29], v[94:97]
    ds_read_b128 v[22:25], v6 offset:3968
    v_mfma_f32_16x16x32_bf16 v[98:101], v[190:193], v[26:29], v[98:101]
    v_mfma_f32_16x16x32_bf16 v[94:97], v[82:85], v[106:109], v[94:97]
    s_waitcnt lgkmcnt(4)
    v_mfma_f32_16x16x32_bf16 v[94:97], v[162:165], v[30:33], v[94:97]
    ds_read_b128 v[26:29], v6 offset:3904
    v_mfma_f32_16x16x32_bf16 v[98:101], v[194:197], v[30:33], v[98:101]
    v_mfma_f32_16x16x32_bf16 v[94:97], v[214:217], v[134:137], v[94:97]
    v_mfma_f32_16x16x32_bf16 v[94:97], v[166:169], v[10:13], v[94:97]
    ds_read_b128 v[30:33], v6 offset:3840
    v_mfma_f32_16x16x32_bf16 v[98:101], v[198:201], v[10:13], v[98:101]
    v_mfma_f32_16x16x32_bf16 v[94:97], v[218:221], v[130:133], v[94:97]
    s_waitcnt lgkmcnt(3)
    v_mfma_f32_16x16x32_bf16 v[94:97], v[170:173], v[14:17], v[94:97]
    ds_read_b128 v[10:13], v6 offset:3776
    v_mfma_f32_16x16x32_bf16 v[98:101], v[202:205], v[14:17], v[98:101]
    v_mfma_f32_16x16x32_bf16 v[94:97], v[222:225], v[126:129], v[94:97]
    v_mfma_f32_16x16x32_bf16 v[98:101], v[142:145], v[18:21], v[98:101]
    ds_read_b128 v[14:17], v6 offset:3712
    v_mfma_f32_16x16x32_bf16 v[98:101], v[58:61], v[18:21], v[98:101]
    v_mfma_f32_16x16x32_bf16 v[98:101], v[70:73], v[118:121], v[98:101]
    v_mfma_f32_16x16x32_bf16 v[98:101], v[74:77], v[122:125], v[98:101]
    s_waitcnt lgkmcnt(3)
    v_mfma_f32_16x16x32_bf16 v[98:101], v[146:149], v[22:25], v[98:101]
    ds_read_b128 v[18:21], v6 offset:3648
    ds_write_b128 v7, v[94:97] offset:6144
    v_mfma_f32_16x16x32_bf16 v[98:101], v[78:81], v[110:113], v[98:101]
    ds_write_b32 v8, v8 offset:128
    v_mfma_f32_16x16x32_bf16 v[98:101], v[82:85], v[114:117], v[98:101]
    v_mfma_f32_16x16x32_bf16 v[98:101], v[150:153], v[26:29], v[98:101]
    ds_read_b128 v[22:25], v6 offset:3584
    v_mfma_f32_16x16x32_bf16 v[98:101], v[230:233], v[102:105], v[98:101]
    s_waitcnt lgkmcnt(5)
    v_mfma_f32_16x16x32_bf16 v[98:101], v[154:157], v[30:33], v[98:101]
    v_mfma_f32_16x16x32_bf16 v[98:101], v[234:237], v[106:109], v[98:101]
    v_mfma_f32_16x16x32_bf16 v[98:101], v[158:161], v[10:13], v[98:101]
    v_mfma_f32_16x16x32_bf16 v[98:101], v[214:217], v[138:141], v[98:101]
    s_waitcnt lgkmcnt(3)
    v_mfma_f32_16x16x32_bf16 v[98:101], v[162:165], v[14:17], v[98:101]
    v_mfma_f32_16x16x32_bf16 v[98:101], v[218:221], v[134:137], v[98:101]
    v_mfma_f32_16x16x32_bf16 v[98:101], v[166:169], v[18:21], v[98:101]
    v_mfma_f32_16x16x32_bf16 v[98:101], v[222:225], v[130:133], v[98:101]
    s_waitcnt lgkmcnt(0)
    v_mfma_f32_16x16x32_bf16 v[98:101], v[170:173], v[22:25], v[98:101]
    v_mfma_f32_16x16x32_bf16 v[98:101], v[226:229], v[126:129], v[98:101]
    s_nop 7
    ds_write_b128 v7, v[98:101] offset:7168
    ds_write_b32 v8, v8 offset:144
    s_branch Lfin
LMw1:
    s_mov_b32 s61, 0
Lfw42:
    ds_read_b32 v254, v9 offset:4
    s_add_u32 s61, s61, 1
    s_waitcnt lgkmcnt(0)
    v_cmp_eq_u32 vcc, 0, v254
    s_cmp_ge_u32 s61, 4194304
    s_cbranch_scc1 Lfd43
    s_cbranch_vccnz Lfw42
Lfd43:
    s_branch LMb1
LMw2:
    s_mov_b32 s61, 0
Lfw44:
    ds_read_b32 v254, v9 offset:8
    s_add_u32 s61, s61, 1
    s_waitcnt lgkmcnt(0)
    v_cmp_eq_u32 vcc, 0, v254
    s_cmp_ge_u32 s61, 4194304
    s_cbranch_scc1 Lfd45
    s_cbranch_vccnz Lfw44
Lfd45:
    s_mov_b32 s61, 0
Lfw46:
    ds_read_b32 v254, v9 offset:12
    s_add_u32 s61, s61, 1
    s_waitcnt lgkmcnt(0)
    v_cmp_eq_u32 vcc, 0, v254
    s_cmp_ge_u32 s61, 4194304
    s_cbranch_scc1 Lfd47
    s_cbranch_vccnz Lfw46
Lfd47:
    s_branch LMb2
LMw4:
    s_mov_b32 s61, 0
Lfw48:
    ds_read_b32 v254, v9 offset:16
    s_add_u32 s61, s61, 1
    s_waitcnt lgkmcnt(0)
    v_cmp_eq_u32 vcc, 0, v254
    s_cmp_ge_u32 s61, 4194304
    s_cbranch_scc1 Lfd49
    s_cbranch_vccnz Lfw48
Lfd49:
    s_mov_b32 s61, 0
Lfw50:
    ds_read_b32 v254, v9 offset:20
    s_add_u32 s61, s61, 1
    s_waitcnt lgkmcnt(0)
    v_cmp_eq_u32 vcc, 0, v254
    s_cmp_ge_u32 s61, 4194304
    s_cbranch_scc1 Lfd51
    s_cbranch_vccnz Lfw50
Lfd51:
    s_branch LMb4
LMw6:
    s_mov_b32 s61, 0
Lfw52:
    ds_read_b32 v254, v9 offset:24
    s_add_u32 s61, s61, 1
    s_waitcnt lgkmcnt(0)
    v_cmp_eq_u32 vcc, 0, v254
    s_cmp_ge_u32 s61, 4194304
    s_cbranch_scc1 Lfd53
    s_cbranch_vccnz Lfw52
Lfd53:
    s_mov_b32 s61, 0
Lfw54:
    ds_read_b32 v254, v9 offset:28
    s_add_u32 s61, s61, 1
    s_waitcnt lgkmcnt(0)
    v_cmp_eq_u32 vcc, 0, v254
    s_cmp_ge_u32 s61, 4194304
    s_cbranch_scc1 Lfd55
    s_cbranch_vccnz Lfw54
Lfd55:
    s_branch LMb6
LH:
    s_lshl_b32 s3, s46, 3
    s_load_dword s5, s[44:45], 0
    v_mov_b32 v19, v9
    s_mov_b32 s52, s40
    s_mov_b32 s53, s41
    s_mov_b32 s54, 2621440
    s_mov_b32 s55, 0x00020000
    v_mul_u32_u24 v2, 5120, v0
    v_add_u32 v3, 1310720, v2
    s_lshl_b32 s60, s4, 2
    s_add_u32 s60, s60, 150432
    v_mov_b32 v18, s60
    v_mov_b32 v9, 150432
    s_lshl_b32 s60, s4, 4
    v_add_u32 v5, s60, v9
    v_mov_b32 v200, 0x3F80
    v_mov_b32 v201, 0x3F80
    ds_write_b64 v19, v[200:201]
    v_add_u32 v12, 0, v0
    v_mul_u32_u24 v13, 43691, v12
    v_lshrrev_b32 v13, 17, v13
    v_add_u32 v12, v12, v13
    v_lshlrev_b32 v236, 5, v12
    v_add_u32 v12, 256, v0
    v_mul_u32_u24 v13, 43691, v12
    v_lshrrev_b32 v13, 17, v13
    v_add_u32 v12, v12, v13
    v_lshlrev_b32 v237, 5, v12
    v_lshlrev_b32 v7, 3, v0
    v_add_u32 v7, 132512, v7
    v_bfe_u32 v8, v0, 3, 2
    v_xor_b32 v8, v8, v0
    v_lshlrev_b32 v8, 4, v8
    v_add_u32 v60, 65472, v8
    v_lshrrev_b32 v230, 4, v1
    v_and_b32 v231, 7, v1
    v_lshlrev_b32 v231, 4, v231
    v_add_u32 v231, 151712, v231
    v_mul_u32_u24 v232, 4608, v230
    v_add_u32 v232, 132512, v232
    v_mul_u32_u24 v233, 32736, v230
    v_lshlrev_b32 v234, 2, v1
    v_add_u32 v234, 150688, v234
    v_lshl_add_u32 v235, v230, 1, v231
    s_mov_b32 s30, 3216550459
    s_mov_b32 s31, 1.0
    s_waitcnt vmcnt(8)
    s_mov_b32 s60, 1069066811
    s_mov_b32 s61, 1042479491
    v_lshlrev_b32 v208, 16, v196
    v_lshlrev_b32 v210, 16, v192
    v_and_b32 v211, 0xffff0000, v192
    v_mul_f32 v208, s60, v208
    v_mul_f32 v210, s60, v210
    v_mul_f32 v211, s60, v211
    v_exp_f32 v208, v208
    v_exp_f32 v210, v210
    v_exp_f32 v211, v211
    v_lshlrev_b32 v212, 16, v193
    v_and_b32 v213, 0xffff0000, v193
    v_cvt_pk_bf16_f32 v208, v208, v208
    v_cvt_pk_bf16_f32 v214, v210, v211
    v_and_b32 v208, 0xffff0000, v208
    v_lshlrev_b32 v210, 16, v214
    v_and_b32 v211, 0xffff0000, v214
    v_pk_mul_f32 v[210:211], v[210:211], v[208:209] op_sel_hi:[1,0]
    v_pk_mul_f32 v[212:213], v[212:213], v[208:209] op_sel_hi:[1,0]
    v_pk_mul_f32 v[210:211], v[210:211], s[60:61] op_sel_hi:[1,0]
    v_pk_mul_f32 v[212:213], v[212:213], s[60:61] op_sel:[0,1] op_sel_hi:[1,1]
    v_mul_f32 v214, 0xc1000000, v210
    v_mul_f32 v215, 0x41000000, v212
    v_exp_f32 v214, v214
    v_fract_f32 v215, v215
    v_cos_f32 v216, v215
    v_sin_f32 v217, v215
    s_nop 0
    v_pk_mul_f32 v[216:217], v[216:217], v[214:215] op_sel_hi:[1,0]
    v_mul_f32 v214, 0xc1000000, v211
    v_mul_f32 v215, 0x41000000, v213
    v_exp_f32 v214, v214
    v_fract_f32 v215, v215
    v_cos_f32 v218, v215
    v_sin_f32 v219, v215
    s_nop 0
    v_pk_mul_f32 v[218:219], v[218:219], v[214:215] op_sel_hi:[1,0]
    v_cvt_pk_bf16_f32 v202, v216, v217
    v_cvt_pk_bf16_f32 v203, v218, v219
    ds_write_b64 v19, v[202:203] offset:528
    v_pk_mul_f32 v[214:215], v[216:217], v[216:217] op_sel_hi:[1,0]
    v_pk_fma_f32 v[220:221], v[216:217], v[216:217], v[214:215] op_sel:[1,1,0] op_sel_hi:[0,1,1] neg_lo:[1,0,0]
    v_pk_mul_f32 v[214:215], v[218:219], v[218:219] op_sel_hi:[1,0]
    v_pk_fma_f32 v[222:223], v[218:219], v[218:219], v[214:215] op_sel:[1,1,0] op_sel_hi:[0,1,1] neg_lo:[1,0,0]
    v_cvt_pk_bf16_f32 v204, v220, v221
    v_cvt_pk_bf16_f32 v205, v222, v223
    ds_write_b64 v19, v[204:205] offset:1056
    v_pk_mul_f32 v[214:215], v[220:221], v[216:217] op_sel_hi:[1,0]
    v_pk_fma_f32 v[220:221], v[220:221], v[216:217], v[214:215] op_sel:[1,1,0] op_sel_hi:[0,1,1] neg_lo:[1,0,0]
    v_pk_mul_f32 v[214:215], v[222:223], v[218:219] op_sel_hi:[1,0]
    v_pk_fma_f32 v[222:223], v[222:223], v[218:219], v[214:215] op_sel:[1,1,0] op_sel_hi:[0,1,1] neg_lo:[1,0,0]
    v_cvt_pk_bf16_f32 v206, v220, v221
    v_cvt_pk_bf16_f32 v207, v222, v223
    ds_write_b64 v19, v[206:207] offset:1584
    v_pk_mul_f32 v[214:215], v[220:221], v[216:217] op_sel_hi:[1,0]
    v_pk_fma_f32 v[220:221], v[220:221], v[216:217], v[214:215] op_sel:[1,1,0] op_sel_hi:[0,1,1] neg_lo:[1,0,0]
    v_pk_mul_f32 v[214:215], v[222:223], v[218:219] op_sel_hi:[1,0]
    v_pk_fma_f32 v[222:223], v[222:223], v[218:219], v[214:215] op_sel:[1,1,0] op_sel_hi:[0,1,1] neg_lo:[1,0,0]
    v_cvt_pk_bf16_f32 v200, v220, v221
    v_cvt_pk_bf16_f32 v201, v222, v223
    ds_write_b64 v19, v[200:201] offset:2112
    v_pk_mul_f32 v[214:215], v[220:221], v[216:217] op_sel_hi:[1,0]
    v_pk_fma_f32 v[220:221], v[220:221], v[216:217], v[214:215] op_sel:[1,1,0] op_sel_hi:[0,1,1] neg_lo:[1,0,0]
    v_pk_mul_f32 v[214:215], v[222:223], v[218:219] op_sel_hi:[1,0]
    v_pk_fma_f32 v[222:223], v[222:223], v[218:219], v[214:215] op_sel:[1,1,0] op_sel_hi:[0,1,1] neg_lo:[1,0,0]
    v_cvt_pk_bf16_f32 v202, v220, v221
    v_cvt_pk_bf16_f32 v203, v222, v223
    ds_write_b64 v19, v[202:203] offset:2640
    v_pk_mul_f32 v[214:215], v[220:221], v[216:217] op_sel_hi:[1,0]
    v_pk_fma_f32 v[220:221], v[220:221], v[216:217], v[214:215] op_sel:[1,1,0] op_sel_hi:[0,1,1] neg_lo:[1,0,0]
    v_pk_mul_f32 v[214:215], v[222:223], v[218:219] op_sel_hi:[1,0]
    v_pk_fma_f32 v[222:223], v[222:223], v[218:219], v[214:215] op_sel:[1,1,0] op_sel_hi:[0,1,1] neg_lo:[1,0,0]
    v_cvt_pk_bf16_f32 v204, v220, v221
    v_cvt_pk_bf16_f32 v205, v222, v223
    ds_write_b64 v19, v[204:205] offset:3168
    v_pk_mul_f32 v[214:215], v[220:221], v[216:217] op_sel_hi:[1,0]
    v_pk_fma_f32 v[220:221], v[220:221], v[216:217], v[214:215] op_sel:[1,1,0] op_sel_hi:[0,1,1] neg_lo:[1,0,0]
    v_pk_mul_f32 v[214:215], v[222:223], v[218:219] op_sel_hi:[1,0]
    v_pk_fma_f32 v[222:223], v[222:223], v[218:219], v[214:215] op_sel:[1,1,0] op_sel_hi:[0,1,1] neg_lo:[1,0,0]
    v_cvt_pk_bf16_f32 v206, v220, v221
    v_cvt_pk_bf16_f32 v207, v222, v223
    ds_write_b64 v19, v[206:207] offset:3696
    v_pk_mul_f32 v[214:215], v[220:221], v[216:217] op_sel_hi:[1,0]
    v_pk_fma_f32 v[220:221], v[220:221], v[216:217], v[214:215] op_sel:[1,1,0] op_sel_hi:[0,1,1] neg_lo:[1,0,0]
    v_pk_mul_f32 v[214:215], v[222:223], v[218:219] op_sel_hi:[1,0]
    v_pk_fma_f32 v[222:223], v[222:223], v[218:219], v[214:215] op_sel:[1,1,0] op_sel_hi:[0,1,1] neg_lo:[1,0,0]
    v_cvt_pk_bf16_f32 v200, v220, v221
    v_cvt_pk_bf16_f32 v201, v222, v223
    ds_write_b64 v19, v[200:201] offset:4224
    v_pk_mul_f32 v[214:215], v[220:221], v[216:217] op_sel_hi:[1,0]
    v_pk_fma_f32 v[220:221], v[220:221], v[216:217], v[214:215] op_sel:[1,1,0] op_sel_hi:[0,1,1] neg_lo:[1,0,0]
    v_pk_mul_f32 v[214:215], v[222:223], v[218:219] op_sel_hi:[1,0]
    v_pk_fma_f32 v[222:223], v[222:223], v[218:219], v[214:215] op_sel:[1,1,0] op_sel_hi:[0,1,1] neg_lo:[1,0,0]
    v_cvt_pk_bf16_f32 v202, v220, v221
    v_cvt_pk_bf16_f32 v203, v222, v223
    ds_write_b64 v19, v[202:203] offset:4752
    v_pk_mul_f32 v[214:215], v[220:221], v[216:217] op_sel_hi:[1,0]
    v_pk_fma_f32 v[220:221], v[220:221], v[216:217], v[214:215] op_sel:[1,1,0] op_sel_hi:[0,1,1] neg_lo:[1,0,0]
    v_pk_mul_f32 v[214:215], v[222:223], v[218:219] op_sel_hi:[1,0]
    v_pk_fma_f32 v[222:223], v[222:223], v[218:219], v[214:215] op_sel:[1,1,0] op_sel_hi:[0,1,1] neg_lo:[1,0,0]
    v_cvt_pk_bf16_f32 v204, v220, v221
    v_cvt_pk_bf16_f32 v205, v222, v223
    ds_write_b64 v19, v[204:205] offset:5280
    s_waitcnt vmcnt(0)
    buffer_load_dwordx2 v[20:21], v2, s[12:15], s3 offen offset:0
Lel56:
    s_mov_b32 s62, 0x3F803F80
    s_mov_b32 s63, 0x3ACCCCCD
    v_dot2_f32_bf16 v96, v64, s62, 0
    v_dot2_f32_bf16 v100, v64, v64, 0
    v_dot2_f32_bf16 v104, v64, v82, 0
    v_dot2_f32_bf16 v97, v70, s62, 0
    v_dot2_f32_bf16 v101, v70, v70, 0
    v_dot2_f32_bf16 v105, v70, v82, 0
    v_dot2_f32_bf16 v98, v76, s62, 0
    v_dot2_f32_bf16 v102, v76, v76, 0
    v_dot2_f32_bf16 v106, v76, v82, 0
    v_dot2_f32_bf16 v99, v82, s62, 0
    v_dot2_f32_bf16 v96, v65, s62, v96
    v_dot2_f32_bf16 v100, v65, v65, v100
    v_dot2_f32_bf16 v104, v65, v83, v104
    v_dot2_f32_bf16 v97, v71, s62, v97
    v_dot2_f32_bf16 v101, v71, v71, v101
    v_dot2_f32_bf16 v105, v71, v83, v105
    v_dot2_f32_bf16 v98, v77, s62, v98
    v_dot2_f32_bf16 v102, v77, v77, v102
    v_dot2_f32_bf16 v106, v77, v83, v106
    v_dot2_f32_bf16 v99, v83, s62, v99
    v_dot2_f32_bf16 v96, v66, s62, v96
    v_dot2_f32_bf16 v100, v66, v66, v100
    v_dot2_f32_bf16 v104, v66, v84, v104
    v_dot2_f32_bf16 v97, v72, s62, v97
    v_dot2_f32_bf16 v101, v72, v72, v101
    v_dot2_f32_bf16 v105, v72, v84, v105
    v_dot2_f32_bf16 v98, v78, s62, v98
    v_dot2_f32_bf16 v102, v78, v78, v102
    v_dot2_f32_bf16 v106, v78, v84, v106
    v_dot2_f32_bf16 v99, v84, s62, v99
    v_dot2_f32_bf16 v96, v67, s62, v96
    v_dot2_f32_bf16 v100, v67, v67, v100
    v_dot2_f32_bf16 v104, v67, v85, v104
    v_dot2_f32_bf16 v97, v73, s62, v97
    v_dot2_f32_bf16 v101, v73, v73, v101
    v_dot2_f32_bf16 v105, v73, v85, v105
    v_dot2_f32_bf16 v98, v79, s62, v98
    v_dot2_f32_bf16 v102, v79, v79, v102
    v_dot2_f32_bf16 v106, v79, v85, v106
    v_dot2_f32_bf16 v99, v85, s62, v99
    v_dot2_f32_bf16 v96, v68, s62, v96
    v_dot2_f32_bf16 v100, v68, v68, v100
    v_dot2_f32_bf16 v104, v68, v86, v104
    v_dot2_f32_bf16 v97, v74, s62, v97
    v_dot2_f32_bf16 v101, v74, v74, v101
    v_dot2_f32_bf16 v105, v74, v86, v105
    v_dot2_f32_bf16 v98, v80, s62, v98
    v_dot2_f32_bf16 v102, v80, v80, v102
    v_dot2_f32_bf16 v106, v80, v86, v106
    v_dot2_f32_bf16 v99, v86, s62, v99
    v_lshrrev_b32 v110, 4, v1
    v_cmp_eq_u32 vcc, 3, v110
    s_and_b32 s60, s4, 3
    s_mul_i32 s61, s60, 3
    s_lshl_b32 s60, s60, 4
    s_add_u32 s60, s60, 151968
    v_lshl_add_u32 v109, v110, 2, s60
    v_add_u32 v108, s61, v110
    v_cndmask_b32 v108, v108, 30, vcc
    v_and_b32 v111, 1, v108
    v_lshrrev_b32 v108, 1, v108
    v_lshlrev_b32 v108, 4, v108
    v_add_u32 v108, 151968, v108
    v_lshl_add_u32 v112, v111, 2, v108
    v_lshl_add_u32 v113, v111, 1, v108
    v_permlane32_swap_b32 v96, v98
    v_permlane32_swap_b32 v97, v99
    v_permlane32_swap_b32 v100, v102
    v_permlane32_swap_b32 v101, v103
    v_permlane32_swap_b32 v104, v106
    v_permlane32_swap_b32 v105, v107
    v_add_f32 v96, v96, v98
    v_add_f32 v97, v97, v99
    v_add_f32 v100, v100, v102
    v_add_f32 v101, v101, v103
    v_add_f32 v104, v104, v106
    v_add_f32 v105, v105, v107
    v_permlane16_swap_b32 v96, v97
    v_permlane16_swap_b32 v100, v101
    v_permlane16_swap_b32 v104, v105
    v_add_f32 v96, v96, v97
    v_add_f32 v100, v100, v101
    v_add_f32 v104, v104, v105
    v_add_f32_dpp v96, v96, v96 row_ror:8 row_mask:0xf bank_mask:0xf
    v_add_f32_dpp v100, v100, v100 row_ror:8 row_mask:0xf bank_mask:0xf
    v_add_f32_dpp v104, v104, v104 row_ror:8 row_mask:0xf bank_mask:0xf
    v_add_f32_dpp v96, v96, v96 row_ror:4 row_mask:0xf bank_mask:0xf
    v_add_f32_dpp v100, v100, v100 row_ror:4 row_mask:0xf bank_mask:0xf
    v_add_f32_dpp v104, v104, v104 row_ror:4 row_mask:0xf bank_mask:0xf
    v_add_f32_dpp v96, v96, v96 row_ror:2 row_mask:0xf bank_mask:0xf
    v_add_f32_dpp v100, v100, v100 row_ror:2 row_mask:0xf bank_mask:0xf
    v_add_f32_dpp v104, v104, v104 row_ror:2 row_mask:0xf bank_mask:0xf
    v_add_f32_dpp v96, v96, v96 row_ror:1 row_mask:0xf bank_mask:0xf
    v_add_f32_dpp v100, v100, v100 row_ror:1 row_mask:0xf bank_mask:0xf
    v_add_f32_dpp v104, v104, v104 row_ror:1 row_mask:0xf bank_mask:0xf
    v_readlane_b32 s60, v96, 48
    v_mul_f32 v96, s63, v96
    v_mul_f32 v100, s63, v100
    v_fma_f32 v100, -v96, v96, v100
    v_max_f32 v100, 0, v100
    v_cvt_pk_bf16_f32 v100, v100, v100
    v_and_b32 v100, 0xffff0000, v100
    v_add_f32 v100, 0x3727C5AC, v100
    v_cvt_pk_bf16_f32 v100, v100, v100
    v_and_b32 v100, 0xffff0000, v100
    v_sqrt_f32 v100, v100
    v_add_u32 v101, s56, v110
    s_movk_i32 s63, 0x800
    v_cvt_pk_bf16_f32 v97, v96, v100
    v_cmp_gt_u32 s[100:101], s63, v101
    v_sub_u32 v101, 0xfff, v101
    v_lshlrev_b32 v96, 16, v97
    v_and_b32 v100, 0xffff0000, v97
    v_rcp_f32 v100, v100
    ds_write_b16 v113, v97 offset:8
    v_fma_f32 v104, -v96, s60, v104
    v_mul_f32 v104, v104, v100
    ds_write_b32 v112, v100
    v_cvt_pk_bf16_f32 v104, v104, v104
    v_and_b32 v104, 0xffff0000, v104
    v_ashrrev_i32 v97, 31, v104
    v_or_b32 v97, 0x80000000, v97
    v_and_b32 v97, 0xffff0000, v97
    v_xor_b32 v104, v104, v97
    v_or_b32 v104, v104, v101
    v_cndmask_b32 v104, 0, v104, s[100:101]
    ds_write_b32 v109, v104 offset:160
    v_mov_b32 v96, 151968
    v_mov_b32 v97, 1
    s_waitcnt lgkmcnt(0)
    s_mul_i32 s5, s5, 0x9E3779B1
    s_add_u32 s5, s5, 0x3C6EF35F
    s_mov_b64 exec, 1
    ds_add_rtn_u32 v97, v96, v97 offset:224
    s_mov_b64 exec, -1
    v_and_b32 v100, 15, v1
    v_lshl_add_u32 v100, v100, 2, v96
    ds_read_b32 v101, v100 offset:160
    v_lshl_add_u32 v102, v110, 4, v96
    ds_read_b128 v[112:115], v102 offset:160
    s_waitcnt lgkmcnt(2)
    v_readfirstlane_b32 s60, v97
    s_nop 0
    s_cmp_lg_u32 s60, 3
    s_cbranch_scc1 Llnp57
    v_mov_b32 v104, 0
    s_waitcnt lgkmcnt(0)
    v_cmp_gt_u32 s[60:61], v112, v101
    v_cmp_gt_u32 s[62:63], v113, v101
    v_cmp_gt_u32 s[100:101], v114, v101
    v_addc_co_u32 v104, vcc, 0, v104, s[60:61]
    v_addc_co_u32 v104, vcc, 0, v104, s[62:63]
    v_addc_co_u32 v104, vcc, 0, v104, s[100:101]
    v_mov_b32 v105, v104
    s_nop 1
    v_permlane32_swap_b32 v104, v105
    v_add_u32 v104, v104, v105
    v_mov_b32 v105, v104
    s_nop 1
    v_permlane16_swap_b32 v104, v105
    v_add_u32 v104, v104, v105
    v_mul_u32_u24 v105, 11, v104
    v_lshrrev_b32 v105, 5, v105
    v_add_u32 v104, v104, v105
    v_lshl_add_u32 v104, v104, 2, v96
    s_mov_b64 exec, 0x7777
    ds_write_b32 v104, v101 offset:96
    s_mov_b64 exec, 0x1ff
    v_lshlrev_b32 v100, 4, v1
    v_add_u32 v101, v100, v96
    s_mul_i32 s61, s46, 112
    s_sub_u32 s61, 36864, s61
    v_writelane_b32 v100, s61, 6
    ds_read_b128 v[112:115], v101
    s_mul_i32 s61, s46, 112
    s_sub_u32 s61, 25600, s61
    v_writelane_b32 v100, s61, 8
    s_lshl_b32 s60, s46, 7
    s_add_u32 s60, s60, 4096
    s_waitcnt lgkmcnt(0)
    v_mov_b32 v115, s5
    buffer_store_dwordx4 v[112:115], v100, s[8:11], s60 offen sc1
    s_mov_b64 exec, -1
Llnp57:
    v_pk_mul_f32 v[214:215], v[220:221], v[216:217] op_sel_hi:[1,0]
    v_pk_fma_f32 v[220:221], v[220:221], v[216:217], v[214:215] op_sel:[1,1,0] op_sel_hi:[0,1,1] neg_lo:[1,0,0]
    v_pk_mul_f32 v[214:215], v[222:223], v[218:219] op_sel_hi:[1,0]
    v_pk_fma_f32 v[222:223], v[222:223], v[218:219], v[214:215] op_sel:[1,1,0] op_sel_hi:[0,1,1] neg_lo:[1,0,0]
    v_cvt_pk_bf16_f32 v206, v220, v221
    v_cvt_pk_bf16_f32 v207, v222, v223
    ds_write_b64 v19, v[206:207] offset:5808
    v_pk_mul_f32 v[214:215], v[220:221], v[216:217] op_sel_hi:[1,0]
    v_pk_fma_f32 v[220:221], v[220:221], v[216:217], v[214:215] op_sel:[1,1,0] op_sel_hi:[0,1,1] neg_lo:[1,0,0]
    v_pk_mul_f32 v[214:215], v[222:223], v[218:219] op_sel_hi:[1,0]
    v_pk_fma_f32 v[222:223], v[222:223], v[218:219], v[214:215] op_sel:[1,1,0] op_sel_hi:[0,1,1] neg_lo:[1,0,0]
    v_cvt_pk_bf16_f32 v200, v220, v221
    v_cvt_pk_bf16_f32 v201, v222, v223
    ds_write_b64 v19, v[200:201] offset:6336
    buffer_load_dwordx2 v[22:23], v2, s[12:15], s3 offen offset:1280
Lel58:
    v_pk_mul_f32 v[214:215], v[220:221], v[216:217] op_sel_hi:[1,0]
    v_pk_fma_f32 v[220:221], v[220:221], v[216:217], v[214:215] op_sel:[1,1,0] op_sel_hi:[0,1,1] neg_lo:[1,0,0]
    v_pk_mul_f32 v[214:215], v[222:223], v[218:219] op_sel_hi:[1,0]
    v_pk_fma_f32 v[222:223], v[222:223], v[218:219], v[214:215] op_sel:[1,1,0] op_sel_hi:[0,1,1] neg_lo:[1,0,0]
    v_cvt_pk_bf16_f32 v202, v220, v221
    v_cvt_pk_bf16_f32 v203, v222, v223
    ds_write_b64 v19, v[202:203] offset:6864
    v_pk_mul_f32 v[214:215], v[220:221], v[216:217] op_sel_hi:[1,0]
    v_pk_fma_f32 v[220:221], v[220:221], v[216:217], v[214:215] op_sel:[1,1,0] op_sel_hi:[0,1,1] neg_lo:[1,0,0]
    v_pk_mul_f32 v[214:215], v[222:223], v[218:219] op_sel_hi:[1,0]
    v_pk_fma_f32 v[222:223], v[222:223], v[218:219], v[214:215] op_sel:[1,1,0] op_sel_hi:[0,1,1] neg_lo:[1,0,0]
    v_cvt_pk_bf16_f32 v204, v220, v221
    v_cvt_pk_bf16_f32 v205, v222, v223
    ds_write_b64 v19, v[204:205] offset:7392
    v_pk_mul_f32 v[214:215], v[220:221], v[216:217] op_sel_hi:[1,0]
    v_pk_fma_f32 v[220:221], v[220:221], v[216:217], v[214:215] op_sel:[1,1,0] op_sel_hi:[0,1,1] neg_lo:[1,0,0]
    v_pk_mul_f32 v[214:215], v[222:223], v[218:219] op_sel_hi:[1,0]
    v_pk_fma_f32 v[222:223], v[222:223], v[218:219], v[214:215] op_sel:[1,1,0] op_sel_hi:[0,1,1] neg_lo:[1,0,0]
    v_cvt_pk_bf16_f32 v206, v220, v221
    v_cvt_pk_bf16_f32 v207, v222, v223
    ds_write_b64 v19, v[206:207] offset:7920
    v_pk_mul_f32 v[214:215], v[220:221], v[216:217] op_sel_hi:[1,0]
    v_pk_fma_f32 v[220:221], v[220:221], v[216:217], v[214:215] op_sel:[1,1,0] op_sel_hi:[0,1,1] neg_lo:[1,0,0]
    v_pk_mul_f32 v[214:215], v[222:223], v[218:219] op_sel_hi:[1,0]
    v_pk_fma_f32 v[222:223], v[222:223], v[218:219], v[214:215] op_sel:[1,1,0] op_sel_hi:[0,1,1] neg_lo:[1,0,0]
    v_cvt_pk_bf16_f32 v200, v220, v221
    v_cvt_pk_bf16_f32 v201, v222, v223
    ds_write_b64 v19, v[200:201] offset:8448
    v_pk_mul_f32 v[214:215], v[220:221], v[216:217] op_sel_hi:[1,0]
    v_pk_fma_f32 v[220:221], v[220:221], v[216:217], v[214:215] op_sel:[1,1,0] op_sel_hi:[0,1,1] neg_lo:[1,0,0]
    v_pk_mul_f32 v[214:215], v[222:223], v[218:219] op_sel_hi:[1,0]
    v_pk_fma_f32 v[222:223], v[222:223], v[218:219], v[214:215] op_sel:[1,1,0] op_sel_hi:[0,1,1] neg_lo:[1,0,0]
    v_cvt_pk_bf16_f32 v202, v220, v221
    v_cvt_pk_bf16_f32 v203, v222, v223
    ds_write_b64 v19, v[202:203] offset:8976
    buffer_load_dwordx2 v[24:25], v2, s[12:15], s3 offen offset:2560
Lel59:
    v_pk_mul_f32 v[214:215], v[220:221], v[216:217] op_sel_hi:[1,0]
    v_pk_fma_f32 v[220:221], v[220:221], v[216:217], v[214:215] op_sel:[1,1,0] op_sel_hi:[0,1,1] neg_lo:[1,0,0]
    v_pk_mul_f32 v[214:215], v[222:223], v[218:219] op_sel_hi:[1,0]
    v_pk_fma_f32 v[222:223], v[222:223], v[218:219], v[214:215] op_sel:[1,1,0] op_sel_hi:[0,1,1] neg_lo:[1,0,0]
    v_cvt_pk_bf16_f32 v204, v220, v221
    v_cvt_pk_bf16_f32 v205, v222, v223
    ds_write_b64 v19, v[204:205] offset:9504
    v_pk_mul_f32 v[214:215], v[220:221], v[216:217] op_sel_hi:[1,0]
    v_pk_fma_f32 v[220:221], v[220:221], v[216:217], v[214:215] op_sel:[1,1,0] op_sel_hi:[0,1,1] neg_lo:[1,0,0]
    v_pk_mul_f32 v[214:215], v[222:223], v[218:219] op_sel_hi:[1,0]
    v_pk_fma_f32 v[222:223], v[222:223], v[218:219], v[214:215] op_sel:[1,1,0] op_sel_hi:[0,1,1] neg_lo:[1,0,0]
    v_cvt_pk_bf16_f32 v206, v220, v221
    v_cvt_pk_bf16_f32 v207, v222, v223
    ds_write_b64 v19, v[206:207] offset:10032
    v_pk_mul_f32 v[214:215], v[220:221], v[216:217] op_sel_hi:[1,0]
    v_pk_fma_f32 v[220:221], v[220:221], v[216:217], v[214:215] op_sel:[1,1,0] op_sel_hi:[0,1,1] neg_lo:[1,0,0]
    v_pk_mul_f32 v[214:215], v[222:223], v[218:219] op_sel_hi:[1,0]
    v_pk_fma_f32 v[222:223], v[222:223], v[218:219], v[214:215] op_sel:[1,1,0] op_sel_hi:[0,1,1] neg_lo:[1,0,0]
    v_cvt_pk_bf16_f32 v200, v220, v221
    v_cvt_pk_bf16_f32 v201, v222, v223
    ds_write_b64 v19, v[200:201] offset:10560
    v_pk_mul_f32 v[214:215], v[220:221], v[216:217] op_sel_hi:[1,0]
    v_pk_fma_f32 v[220:221], v[220:221], v[216:217], v[214:215] op_sel:[1,1,0] op_sel_hi:[0,1,1] neg_lo:[1,0,0]
    v_pk_mul_f32 v[214:215], v[222:223], v[218:219] op_sel_hi:[1,0]
    v_pk_fma_f32 v[222:223], v[222:223], v[218:219], v[214:215] op_sel:[1,1,0] op_sel_hi:[0,1,1] neg_lo:[1,0,0]
    v_cvt_pk_bf16_f32 v202, v220, v221
    v_cvt_pk_bf16_f32 v203, v222, v223
    ds_write_b64 v19, v[202:203] offset:11088
    v_pk_mul_f32 v[214:215], v[220:221], v[216:217] op_sel_hi:[1,0]
    v_pk_fma_f32 v[220:221], v[220:221], v[216:217], v[214:215] op_sel:[1,1,0] op_sel_hi:[0,1,1] neg_lo:[1,0,0]
    v_pk_mul_f32 v[214:215], v[222:223], v[218:219] op_sel_hi:[1,0]
    v_pk_fma_f32 v[222:223], v[222:223], v[218:219], v[214:215] op_sel:[1,1,0] op_sel_hi:[0,1,1] neg_lo:[1,0,0]
    v_cvt_pk_bf16_f32 v204, v220, v221
    v_cvt_pk_bf16_f32 v205, v222, v223
    ds_write_b64 v19, v[204:205] offset:11616
    buffer_load_dwordx2 v[26:27], v2, s[12:15], s3 offen offset:3840
Lel60:
    v_pk_mul_f32 v[214:215], v[220:221], v[216:217] op_sel_hi:[1,0]
    v_pk_fma_f32 v[220:221], v[220:221], v[216:217], v[214:215] op_sel:[1,1,0] op_sel_hi:[0,1,1] neg_lo:[1,0,0]
    v_pk_mul_f32 v[214:215], v[222:223], v[218:219] op_sel_hi:[1,0]
    v_pk_fma_f32 v[222:223], v[222:223], v[218:219], v[214:215] op_sel:[1,1,0] op_sel_hi:[0,1,1] neg_lo:[1,0,0]
    v_cvt_pk_bf16_f32 v206, v220, v221
    v_cvt_pk_bf16_f32 v207, v222, v223
    ds_write_b64 v19, v[206:207] offset:12144
    v_pk_mul_f32 v[214:215], v[220:221], v[216:217] op_sel_hi:[1,0]
    v_pk_fma_f32 v[220:221], v[220:221], v[216:217], v[214:215] op_sel:[1,1,0] op_sel_hi:[0,1,1] neg_lo:[1,0,0]
    v_pk_mul_f32 v[214:215], v[222:223], v[218:219] op_sel_hi:[1,0]
    v_pk_fma_f32 v[222:223], v[222:223], v[218:219], v[214:215] op_sel:[1,1,0] op_sel_hi:[0,1,1] neg_lo:[1,0,0]
    v_cvt_pk_bf16_f32 v200, v220, v221
    v_cvt_pk_bf16_f32 v201, v222, v223
    ds_write_b64 v19, v[200:201] offset:12672
    v_pk_mul_f32 v[214:215], v[220:221], v[216:217] op_sel_hi:[1,0]
    v_pk_fma_f32 v[220:221], v[220:221], v[216:217], v[214:215] op_sel:[1,1,0] op_sel_hi:[0,1,1] neg_lo:[1,0,0]
    v_pk_mul_f32 v[214:215], v[222:223], v[218:219] op_sel_hi:[1,0]
    v_pk_fma_f32 v[222:223], v[222:223], v[218:219], v[214:215] op_sel:[1,1,0] op_sel_hi:[0,1,1] neg_lo:[1,0,0]
    v_cvt_pk_bf16_f32 v202, v220, v221
    v_cvt_pk_bf16_f32 v203, v222, v223
    ds_write_b64 v19, v[202:203] offset:13200
    v_pk_mul_f32 v[214:215], v[220:221], v[216:217] op_sel_hi:[1,0]
    v_pk_fma_f32 v[220:221], v[220:221], v[216:217], v[214:215] op_sel:[1,1,0] op_sel_hi:[0,1,1] neg_lo:[1,0,0]
    v_pk_mul_f32 v[214:215], v[222:223], v[218:219] op_sel_hi:[1,0]
    v_pk_fma_f32 v[222:223], v[222:223], v[218:219], v[214:215] op_sel:[1,1,0] op_sel_hi:[0,1,1] neg_lo:[1,0,0]
    v_cvt_pk_bf16_f32 v204, v220, v221
    v_cvt_pk_bf16_f32 v205, v222, v223
    ds_write_b64 v19, v[204:205] offset:13728
    v_pk_mul_f32 v[214:215], v[220:221], v[216:217] op_sel_hi:[1,0]
    v_pk_fma_f32 v[220:221], v[220:221], v[216:217], v[214:215] op_sel:[1,1,0] op_sel_hi:[0,1,1] neg_lo:[1,0,0]
    v_pk_mul_f32 v[214:215], v[222:223], v[218:219] op_sel_hi:[1,0]
    v_pk_fma_f32 v[222:223], v[222:223], v[218:219], v[214:215] op_sel:[1,1,0] op_sel_hi:[0,1,1] neg_lo:[1,0,0]
    v_cvt_pk_bf16_f32 v206, v220, v221
    v_cvt_pk_bf16_f32 v207, v222, v223
    ds_write_b64 v19, v[206:207] offset:14256
    v_pk_mul_f32 v[214:215], v[220:221], v[216:217] op_sel_hi:[1,0]
    v_pk_fma_f32 v[220:221], v[220:221], v[216:217], v[214:215] op_sel:[1,1,0] op_sel_hi:[0,1,1] neg_lo:[1,0,0]
    v_pk_mul_f32 v[214:215], v[222:223], v[218:219] op_sel_hi:[1,0]
    v_pk_fma_f32 v[222:223], v[222:223], v[218:219], v[214:215] op_sel:[1,1,0] op_sel_hi:[0,1,1] neg_lo:[1,0,0]
    v_cvt_pk_bf16_f32 v200, v220, v221
    v_cvt_pk_bf16_f32 v201, v222, v223
    ds_write_b64 v19, v[200:201] offset:14784
    v_pk_mul_f32 v[214:215], v[220:221], v[216:217] op_sel_hi:[1,0]
    v_pk_fma_f32 v[220:221], v[220:221], v[216:217], v[214:215] op_sel:[1,1,0] op_sel_hi:[0,1,1] neg_lo:[1,0,0]
    v_pk_mul_f32 v[214:215], v[222:223], v[218:219] op_sel_hi:[1,0]
    v_pk_fma_f32 v[222:223], v[222:223], v[218:219], v[214:215] op_sel:[1,1,0] op_sel_hi:[0,1,1] neg_lo:[1,0,0]
    v_cvt_pk_bf16_f32 v202, v220, v221
    v_cvt_pk_bf16_f32 v203, v222, v223
    ds_write_b64 v19, v[202:203] offset:15312
    v_pk_mul_f32 v[214:215], v[220:221], v[216:217] op_sel_hi:[1,0]
    v_pk_fma_f32 v[220:221], v[220:221], v[216:217], v[214:215] op_sel:[1,1,0] op_sel_hi:[0,1,1] neg_lo:[1,0,0]
    v_pk_mul_f32 v[214:215], v[222:223], v[218:219] op_sel_hi:[1,0]
    v_pk_fma_f32 v[222:223], v[222:223], v[218:219], v[214:215] op_sel:[1,1,0] op_sel_hi:[0,1,1] neg_lo:[1,0,0]
    v_cvt_pk_bf16_f32 v204, v220, v221
    v_cvt_pk_bf16_f32 v205, v222, v223
    ds_write_b64 v19, v[204:205] offset:15840
    v_pk_mul_f32 v[214:215], v[220:221], v[216:217] op_sel_hi:[1,0]
    v_pk_fma_f32 v[220:221], v[220:221], v[216:217], v[214:215] op_sel:[1,1,0] op_sel_hi:[0,1,1] neg_lo:[1,0,0]
    v_pk_mul_f32 v[214:215], v[222:223], v[218:219] op_sel_hi:[1,0]
    v_pk_fma_f32 v[222:223], v[222:223], v[218:219], v[214:215] op_sel:[1,1,0] op_sel_hi:[0,1,1] neg_lo:[1,0,0]
    v_cvt_pk_bf16_f32 v206, v220, v221
    v_cvt_pk_bf16_f32 v207, v222, v223
    ds_write_b64 v19, v[206:207] offset:16368
    ds_write_b32 v18, v18 offset:192
    s_movk_i32 s57, 4096
    buffer_load_dwordx4 v[176:179], v236, s[8:11], s57 offen offset:0 sc1
    buffer_load_dwordx4 v[180:183], v236, s[8:11], s57 offen offset:16 sc1
    buffer_load_dwordx4 v[184:187], v237, s[8:11], s57 offen offset:0 sc1
    buffer_load_dwordx4 v[188:191], v237, s[8:11], s57 offen offset:16 sc1
    ds_write_b32 v18, v18 offset:224
    s_mov_b32 s61, 0
Lfw61:
    ds_read_b128 v[12:15], v9 offset:224
    s_add_u32 s61, s61, 1
    s_waitcnt lgkmcnt(0)
    v_min3_u32 v12, v12, v13, v14
    v_min_u32 v12, v12, v15
    v_cmp_eq_u32 vcc, 0, v12
    s_cmp_ge_u32 s61, 4194304
    s_cbranch_scc1 Lfd62
    s_cbranch_vccnz Lfw61
Lfd62:
    buffer_load_dwordx2 v[28:29], v3, s[12:15], s3 offen offset:0
    buffer_load_dwordx2 v[30:31], v3, s[12:15], s3 offen offset:1280
    s_waitcnt vmcnt(6)
    v_lshlrev_b32 v64, 16, v20
    v_and_b32 v68, 0xffff0000, v20
    v_lshlrev_b32 v72, 16, v21
    v_and_b32 v76, 0xffff0000, v21
    v_lshlrev_b32 v65, 16, v22
    v_and_b32 v69, 0xffff0000, v22
    v_lshlrev_b32 v73, 16, v23
    v_and_b32 v77, 0xffff0000, v23
    v_lshlrev_b32 v66, 16, v24
    v_and_b32 v70, 0xffff0000, v24
    v_lshlrev_b32 v74, 16, v25
    v_and_b32 v78, 0xffff0000, v25
    v_lshlrev_b32 v67, 16, v26
    v_and_b32 v71, 0xffff0000, v26
    v_lshlrev_b32 v75, 16, v27
    v_and_b32 v79, 0xffff0000, v27
    s_waitcnt vmcnt(4)
    s_mov_b32 s61, 0
Lsp63:
    v_xor_b32 v12, s5, v179
    v_xor_b32 v13, s5, v183
    v_or_b32 v12, v12, v13
    v_cmp_ne_u32 vcc, 0, v12
    s_nop 0
    s_and_b64 exec, exec, vcc
    s_cbranch_execz Lsd64
    s_add_u32 s61, s61, 1
    s_cmp_ge_u32 s61, 4194304
    s_cbranch_scc1 Lsd64
    buffer_load_dwordx4 v[176:179], v236, s[8:11], s57 offen offset:0 sc1
    buffer_load_dwordx4 v[180:183], v236, s[8:11], s57 offen offset:16 sc1
    s_waitcnt vmcnt(0)
    s_branch Lsp63
Lsd64:
    s_mov_b64 exec, -1
    v_lshlrev_b32 v52, 16, v178
    v_and_b32 v53, 0xffff0000, v178
    v_lshlrev_b32 v54, 16, v182
    v_and_b32 v55, 0xffff0000, v182
    v_pk_add_f32 v[96:97], v[64:65], v[52:53] neg_lo:[0,1] neg_hi:[0,1]
    v_pk_add_f32 v[98:99], v[66:67], v[54:55] neg_lo:[0,1] neg_hi:[0,1]
    v_pk_add_f32 v[100:101], v[68:69], v[52:53] neg_lo:[0,1] neg_hi:[0,1]
    v_pk_add_f32 v[102:103], v[70:71], v[54:55] neg_lo:[0,1] neg_hi:[0,1]
    v_pk_add_f32 v[104:105], v[72:73], v[52:53] neg_lo:[0,1] neg_hi:[0,1]
    v_pk_add_f32 v[106:107], v[74:75], v[54:55] neg_lo:[0,1] neg_hi:[0,1]
    v_pk_add_f32 v[108:109], v[76:77], v[52:53] neg_lo:[0,1] neg_hi:[0,1]
    v_pk_add_f32 v[110:111], v[78:79], v[54:55] neg_lo:[0,1] neg_hi:[0,1]
    v_cvt_pk_bf16_f32 v36, v96, v97
    v_cvt_pk_bf16_f32 v37, v98, v99
    v_cvt_pk_bf16_f32 v38, v100, v101
    v_cvt_pk_bf16_f32 v39, v102, v103
    v_cvt_pk_bf16_f32 v40, v104, v105
    v_cvt_pk_bf16_f32 v41, v106, v107
    v_cvt_pk_bf16_f32 v42, v108, v109
    v_cvt_pk_bf16_f32 v43, v110, v111
    v_lshlrev_b32 v96, 16, v36
    v_and_b32 v97, 0xffff0000, v36
    v_lshlrev_b32 v98, 16, v37
    v_and_b32 v99, 0xffff0000, v37
    v_lshlrev_b32 v100, 16, v38
    v_and_b32 v101, 0xffff0000, v38
    v_lshlrev_b32 v102, 16, v39
    v_and_b32 v103, 0xffff0000, v39
    v_lshlrev_b32 v104, 16, v40
    v_and_b32 v105, 0xffff0000, v40
    v_lshlrev_b32 v106, 16, v41
    v_and_b32 v107, 0xffff0000, v41
    v_lshlrev_b32 v108, 16, v42
    v_and_b32 v109, 0xffff0000, v42
    v_lshlrev_b32 v110, 16, v43
    v_and_b32 v111, 0xffff0000, v43
    v_pk_mul_f32 v[96:97], v[96:97], v[176:177]
    v_pk_mul_f32 v[98:99], v[98:99], v[180:181]
    v_cvt_pk_bf16_f32 v36, v96, v97
    v_cvt_pk_bf16_f32 v37, v98, v99
    ds_write_b64 v7, v[36:37] offset:0
    v_pk_mul_f32 v[100:101], v[100:101], v[176:177]
    v_pk_mul_f32 v[102:103], v[102:103], v[180:181]
    v_cvt_pk_bf16_f32 v38, v100, v101
    v_cvt_pk_bf16_f32 v39, v102, v103
    ds_write_b64 v7, v[38:39] offset:4608
    v_pk_mul_f32 v[104:105], v[104:105], v[176:177]
    v_pk_mul_f32 v[106:107], v[106:107], v[180:181]
    v_cvt_pk_bf16_f32 v40, v104, v105
    v_cvt_pk_bf16_f32 v41, v106, v107
    ds_write_b64 v7, v[40:41] offset:9216
    v_pk_mul_f32 v[108:109], v[108:109], v[176:177]
    v_pk_mul_f32 v[110:111], v[110:111], v[180:181]
    v_cvt_pk_bf16_f32 v42, v108, v109
    v_cvt_pk_bf16_f32 v43, v110, v111
    ds_write_b64 v7, v[42:43] offset:13824
    ds_write_b32 v18, v18 offset:0
    buffer_load_dwordx2 v[32:33], v3, s[12:15], s3 offen offset:2560
    buffer_load_dwordx2 v[34:35], v3, s[12:15], s3 offen offset:3840
    v_lshlrev_b32 v96, 16, v36
    v_and_b32 v97, 0xffff0000, v36
    v_lshlrev_b32 v98, 16, v37
    v_and_b32 v99, 0xffff0000, v37
    v_lshlrev_b32 v100, 16, v38
    v_and_b32 v101, 0xffff0000, v38
    v_lshlrev_b32 v102, 16, v39
    v_and_b32 v103, 0xffff0000, v39
    v_lshlrev_b32 v104, 16, v40
    v_and_b32 v105, 0xffff0000, v40
    v_lshlrev_b32 v106, 16, v41
    v_and_b32 v107, 0xffff0000, v41
    v_lshlrev_b32 v108, 16, v42
    v_and_b32 v109, 0xffff0000, v42
    v_lshlrev_b32 v110, 16, v43
    v_and_b32 v111, 0xffff0000, v43
    v_mul_f32 v128, s30, v96
    v_mul_f32 v129, s30, v97
    v_mul_f32 v130, s30, v98
    v_mul_f32 v131, s30, v99
    v_mul_f32 v132, s30, v100
    v_mul_f32 v133, s30, v101
    v_mul_f32 v134, s30, v102
    v_mul_f32 v135, s30, v103
    v_mul_f32 v136, s30, v104
    v_mul_f32 v137, s30, v105
    v_mul_f32 v138, s30, v106
    v_mul_f32 v139, s30, v107
    v_mul_f32 v140, s30, v108
    v_mul_f32 v141, s30, v109
    v_mul_f32 v142, s30, v110
    v_mul_f32 v143, s30, v111
    v_exp_f32 v128, v128
    v_exp_f32 v129, v129
    v_exp_f32 v130, v130
    v_exp_f32 v131, v131
    v_exp_f32 v132, v132
    v_exp_f32 v133, v133
    v_exp_f32 v134, v134
    v_exp_f32 v135, v135
    v_exp_f32 v136, v136
    v_exp_f32 v137, v137
    v_exp_f32 v138, v138
    v_exp_f32 v139, v139
    v_exp_f32 v140, v140
    v_exp_f32 v141, v141
    v_exp_f32 v142, v142
    v_exp_f32 v143, v143
    v_add_f32 v128, 1.0, v128
    v_add_f32 v129, 1.0, v129
    v_add_f32 v130, 1.0, v130
    v_add_f32 v131, 1.0, v131
    v_add_f32 v132, 1.0, v132
    v_add_f32 v133, 1.0, v133
    v_add_f32 v134, 1.0, v134
    v_add_f32 v135, 1.0, v135
    v_add_f32 v136, 1.0, v136
    v_add_f32 v137, 1.0, v137
    v_add_f32 v138, 1.0, v138
    v_add_f32 v139, 1.0, v139
    v_add_f32 v140, 1.0, v140
    v_add_f32 v141, 1.0, v141
    v_add_f32 v142, 1.0, v142
    v_add_f32 v143, 1.0, v143
    v_rcp_f32 v128, v128
    v_rcp_f32 v129, v129
    v_rcp_f32 v130, v130
    v_rcp_f32 v131, v131
    v_rcp_f32 v132, v132
    v_rcp_f32 v133, v133
    v_rcp_f32 v134, v134
    v_rcp_f32 v135, v135
    v_rcp_f32 v136, v136
    v_rcp_f32 v137, v137
    v_rcp_f32 v138, v138
    v_rcp_f32 v139, v139
    v_rcp_f32 v140, v140
    v_rcp_f32 v141, v141
    v_rcp_f32 v142, v142
    v_rcp_f32 v143, v143
    v_mul_f32 v128, v128, v96
    v_mul_f32 v129, v129, v97
    v_mul_f32 v130, v130, v98
    v_mul_f32 v131, v131, v99
    v_mul_f32 v132, v132, v100
    v_mul_f32 v133, v133, v101
    v_mul_f32 v134, v134, v102
    v_mul_f32 v135, v135, v103
    v_mul_f32 v136, v136, v104
    v_mul_f32 v137, v137, v105
    v_mul_f32 v138, v138, v106
    v_mul_f32 v139, v139, v107
    v_mul_f32 v140, v140, v108
    v_mul_f32 v141, v141, v109
    v_mul_f32 v142, v142, v110
    v_mul_f32 v143, v143, v111
    s_waitcnt vmcnt(0)
    s_cmp_ge_u32 s4, 1
    s_cbranch_scc1 LHe2
    s_mov_b32 s61, 0
Lfw65:
    ds_read_b128 v[12:15], v5 offset:32
    s_add_u32 s61, s61, 1
    s_waitcnt lgkmcnt(0)
    v_min3_u32 v12, v12, v13, v14
    v_min_u32 v12, v12, v15
    v_cmp_eq_u32 vcc, 0, v12
    s_cmp_ge_u32 s61, 4194304
    s_cbranch_scc1 Lfd66
    s_cbranch_vccnz Lfw65
Lfd66:
    ds_read_b128 v[96:99], v8 offset:0
    ds_read_b128 v[100:103], v8 offset:32736
    ds_read_b128 v[104:107], v60 offset:0
    ds_read_b128 v[108:111], v60 offset:32736
    s_waitcnt lgkmcnt(3)
    v_fmac_f32 v64, v96, v128
    v_fmac_f32 v65, v97, v129
    v_fmac_f32 v66, v98, v130
    v_fmac_f32 v67, v99, v131
    s_waitcnt lgkmcnt(2)
    v_fmac_f32 v68, v100, v132
    v_fmac_f32 v69, v101, v133
    v_fmac_f32 v70, v102, v134
    v_fmac_f32 v71, v103, v135
    s_waitcnt lgkmcnt(1)
    v_fmac_f32 v72, v104, v136
    v_fmac_f32 v73, v105, v137
    v_fmac_f32 v74, v106, v138
    v_fmac_f32 v75, v107, v139
    s_waitcnt lgkmcnt(0)
    v_fmac_f32 v76, v108, v140
    v_fmac_f32 v77, v109, v141
    v_fmac_f32 v78, v110, v142
    v_fmac_f32 v79, v111, v143
    v_cvt_pk_bf16_f32 v36, v64, v68
    v_cvt_pk_bf16_f32 v37, v72, v76
    buffer_store_dwordx2 v[36:37], v2, s[52:55], s3 offen offset:0
    v_cvt_pk_bf16_f32 v38, v65, v69
    v_cvt_pk_bf16_f32 v39, v73, v77
    buffer_store_dwordx2 v[38:39], v2, s[52:55], s3 offen offset:1280
    v_cvt_pk_bf16_f32 v40, v66, v70
    v_cvt_pk_bf16_f32 v41, v74, v78
    buffer_store_dwordx2 v[40:41], v2, s[52:55], s3 offen offset:2560
    v_cvt_pk_bf16_f32 v42, v67, v71
    v_cvt_pk_bf16_f32 v43, v75, v79
    buffer_store_dwordx2 v[42:43], v2, s[52:55], s3 offen offset:3840
LHe2:
    v_lshlrev_b32 v80, 16, v28
    v_and_b32 v84, 0xffff0000, v28
    v_lshlrev_b32 v88, 16, v29
    v_and_b32 v92, 0xffff0000, v29
    v_lshlrev_b32 v81, 16, v30
    v_and_b32 v85, 0xffff0000, v30
    v_lshlrev_b32 v89, 16, v31
    v_and_b32 v93, 0xffff0000, v31
    v_lshlrev_b32 v82, 16, v32
    v_and_b32 v86, 0xffff0000, v32
    v_lshlrev_b32 v90, 16, v33
    v_and_b32 v94, 0xffff0000, v33
    v_lshlrev_b32 v83, 16, v34
    v_and_b32 v87, 0xffff0000, v34
    v_lshlrev_b32 v91, 16, v35
    v_and_b32 v95, 0xffff0000, v35
    s_mov_b32 s61, 0
Lsp67:
    v_xor_b32 v12, s5, v187
    v_xor_b32 v13, s5, v191
    v_or_b32 v12, v12, v13
    v_cmp_ne_u32 vcc, 0, v12
    s_nop 0
    s_and_b64 exec, exec, vcc
    s_cbranch_execz Lsd68
    s_add_u32 s61, s61, 1
    s_cmp_ge_u32 s61, 4194304
    s_cbranch_scc1 Lsd68
    buffer_load_dwordx4 v[184:187], v237, s[8:11], s57 offen offset:0 sc1
    buffer_load_dwordx4 v[188:191], v237, s[8:11], s57 offen offset:16 sc1
    s_waitcnt vmcnt(0)
    s_branch Lsp67
Lsd68:
    s_mov_b64 exec, -1
    v_lshlrev_b32 v52, 16, v186
    v_and_b32 v53, 0xffff0000, v186
    v_lshlrev_b32 v54, 16, v190
    v_and_b32 v55, 0xffff0000, v190
    v_sub_f32 v112, v80, v52
    v_sub_f32 v113, v81, v53
    v_sub_f32 v114, v82, v54
    v_sub_f32 v115, v83, v55
    v_sub_f32 v116, v84, v52
    v_sub_f32 v117, v85, v53
    v_sub_f32 v118, v86, v54
    v_sub_f32 v119, v87, v55
    v_sub_f32 v120, v88, v52
    v_sub_f32 v121, v89, v53
    v_sub_f32 v122, v90, v54
    v_sub_f32 v123, v91, v55
    v_sub_f32 v124, v92, v52
    v_sub_f32 v125, v93, v53
    v_sub_f32 v126, v94, v54
    v_sub_f32 v127, v95, v55
    v_cvt_pk_bf16_f32 v44, v112, v113
    v_cvt_pk_bf16_f32 v45, v114, v115
    v_cvt_pk_bf16_f32 v46, v116, v117
    v_cvt_pk_bf16_f32 v47, v118, v119
    v_cvt_pk_bf16_f32 v48, v120, v121
    v_cvt_pk_bf16_f32 v49, v122, v123
    v_cvt_pk_bf16_f32 v50, v124, v125
    v_cvt_pk_bf16_f32 v51, v126, v127
    v_lshlrev_b32 v112, 16, v44
    v_and_b32 v113, 0xffff0000, v44
    v_lshlrev_b32 v114, 16, v45
    v_and_b32 v115, 0xffff0000, v45
    v_lshlrev_b32 v116, 16, v46
    v_and_b32 v117, 0xffff0000, v46
    v_lshlrev_b32 v118, 16, v47
    v_and_b32 v119, 0xffff0000, v47
    v_lshlrev_b32 v120, 16, v48
    v_and_b32 v121, 0xffff0000, v48
    v_lshlrev_b32 v122, 16, v49
    v_and_b32 v123, 0xffff0000, v49
    v_lshlrev_b32 v124, 16, v50
    v_and_b32 v125, 0xffff0000, v50
    v_lshlrev_b32 v126, 16, v51
    v_and_b32 v127, 0xffff0000, v51
    v_mul_f32 v112, v112, v184
    v_mul_f32 v113, v113, v185
    v_mul_f32 v114, v114, v188
    v_mul_f32 v115, v115, v189
    v_cvt_pk_bf16_f32 v44, v112, v113
    v_cvt_pk_bf16_f32 v45, v114, v115
    ds_write_b64 v7, v[44:45] offset:2048
    v_mul_f32 v116, v116, v184
    v_mul_f32 v117, v117, v185
    v_mul_f32 v118, v118, v188
    v_mul_f32 v119, v119, v189
    v_cvt_pk_bf16_f32 v46, v116, v117
    v_cvt_pk_bf16_f32 v47, v118, v119
    ds_write_b64 v7, v[46:47] offset:6656
    v_mul_f32 v120, v120, v184
    v_mul_f32 v121, v121, v185
    v_mul_f32 v122, v122, v188
    v_mul_f32 v123, v123, v189
    v_cvt_pk_bf16_f32 v48, v120, v121
    v_cvt_pk_bf16_f32 v49, v122, v123
    ds_write_b64 v7, v[48:49] offset:11264
    v_mul_f32 v124, v124, v184
    v_mul_f32 v125, v125, v185
    v_mul_f32 v126, v126, v188
    v_mul_f32 v127, v127, v189
    v_cvt_pk_bf16_f32 v50, v124, v125
    v_cvt_pk_bf16_f32 v51, v126, v127
    ds_write_b64 v7, v[50:51] offset:15872
    ds_write_b32 v18, v18 offset:16
    s_cmp_lt_u32 s4, 1
    s_cbranch_scc1 LHo2
    s_cmp_ge_u32 s4, 3
    s_cbranch_scc1 LHo2
    s_mov_b32 s61, 0
Lfw69:
    ds_read_b128 v[12:15], v5 offset:32
    s_add_u32 s61, s61, 1
    s_waitcnt lgkmcnt(0)
    v_min3_u32 v12, v12, v13, v14
    v_min_u32 v12, v12, v15
    v_cmp_eq_u32 vcc, 0, v12
    s_cmp_ge_u32 s61, 4194304
    s_cbranch_scc1 Lfd70
    s_cbranch_vccnz Lfw69
Lfd70:
    ds_read_b128 v[96:99], v8 offset:0
    ds_read_b128 v[100:103], v8 offset:32736
    ds_read_b128 v[104:107], v60 offset:0
    ds_read_b128 v[108:111], v60 offset:32736
    s_waitcnt lgkmcnt(3)
    v_fmac_f32 v64, v96, v128
    v_fmac_f32 v65, v97, v129
    v_fmac_f32 v66, v98, v130
    v_fmac_f32 v67, v99, v131
    s_waitcnt lgkmcnt(2)
    v_fmac_f32 v68, v100, v132
    v_fmac_f32 v69, v101, v133
    v_fmac_f32 v70, v102, v134
    v_fmac_f32 v71, v103, v135
    s_waitcnt lgkmcnt(1)
    v_fmac_f32 v72, v104, v136
    v_fmac_f32 v73, v105, v137
    v_fmac_f32 v74, v106, v138
    v_fmac_f32 v75, v107, v139
    s_waitcnt lgkmcnt(0)
    v_fmac_f32 v76, v108, v140
    v_fmac_f32 v77, v109, v141
    v_fmac_f32 v78, v110, v142
    v_fmac_f32 v79, v111, v143
    v_cvt_pk_bf16_f32 v36, v64, v68
    v_cvt_pk_bf16_f32 v37, v72, v76
    buffer_store_dwordx2 v[36:37], v2, s[52:55], s3 offen offset:0
    v_cvt_pk_bf16_f32 v38, v65, v69
    v_cvt_pk_bf16_f32 v39, v73, v77
    buffer_store_dwordx2 v[38:39], v2, s[52:55], s3 offen offset:1280
    v_cvt_pk_bf16_f32 v40, v66, v70
    v_cvt_pk_bf16_f32 v41, v74, v78
    buffer_store_dwordx2 v[40:41], v2, s[52:55], s3 offen offset:2560
    v_cvt_pk_bf16_f32 v42, v67, v71
    v_cvt_pk_bf16_f32 v43, v75, v79
    buffer_store_dwordx2 v[42:43], v2, s[52:55], s3 offen offset:3840
LHo2:
    v_lshlrev_b32 v112, 16, v44
    v_and_b32 v113, 0xffff0000, v44
    v_lshlrev_b32 v114, 16, v45
    v_and_b32 v115, 0xffff0000, v45
    v_lshlrev_b32 v116, 16, v46
    v_and_b32 v117, 0xffff0000, v46
    v_lshlrev_b32 v118, 16, v47
    v_and_b32 v119, 0xffff0000, v47
    v_lshlrev_b32 v120, 16, v48
    v_and_b32 v121, 0xffff0000, v48
    v_lshlrev_b32 v122, 16, v49
    v_and_b32 v123, 0xffff0000, v49
    v_lshlrev_b32 v124, 16, v50
    v_and_b32 v125, 0xffff0000, v50
    v_lshlrev_b32 v126, 16, v51
    v_and_b32 v127, 0xffff0000, v51
    v_mul_f32 v144, s30, v112
    v_mul_f32 v145, s30, v113
    v_mul_f32 v146, s30, v114
    v_mul_f32 v147, s30, v115
    v_mul_f32 v148, s30, v116
    v_mul_f32 v149, s30, v117
    v_mul_f32 v150, s30, v118
    v_mul_f32 v151, s30, v119
    v_mul_f32 v152, s30, v120
    v_mul_f32 v153, s30, v121
    v_mul_f32 v154, s30, v122
    v_mul_f32 v155, s30, v123
    v_mul_f32 v156, s30, v124
    v_mul_f32 v157, s30, v125
    v_mul_f32 v158, s30, v126
    v_mul_f32 v159, s30, v127
    v_exp_f32 v144, v144
    v_exp_f32 v145, v145
    v_exp_f32 v146, v146
    v_exp_f32 v147, v147
    v_exp_f32 v148, v148
    v_exp_f32 v149, v149
    v_exp_f32 v150, v150
    v_exp_f32 v151, v151
    v_exp_f32 v152, v152
    v_exp_f32 v153, v153
    v_exp_f32 v154, v154
    v_exp_f32 v155, v155
    v_exp_f32 v156, v156
    v_exp_f32 v157, v157
    v_exp_f32 v158, v158
    v_exp_f32 v159, v159
    v_add_f32 v144, 1.0, v144
    v_add_f32 v145, 1.0, v145
    v_add_f32 v146, 1.0, v146
    v_add_f32 v147, 1.0, v147
    v_add_f32 v148, 1.0, v148
    v_add_f32 v149, 1.0, v149
    v_add_f32 v150, 1.0, v150
    v_add_f32 v151, 1.0, v151
    v_add_f32 v152, 1.0, v152
    v_add_f32 v153, 1.0, v153
    v_add_f32 v154, 1.0, v154
    v_add_f32 v155, 1.0, v155
    v_add_f32 v156, 1.0, v156
    v_add_f32 v157, 1.0, v157
    v_add_f32 v158, 1.0, v158
    v_add_f32 v159, 1.0, v159
    v_rcp_f32 v144, v144
    v_rcp_f32 v145, v145
    v_rcp_f32 v146, v146
    v_rcp_f32 v147, v147
    v_rcp_f32 v148, v148
    v_rcp_f32 v149, v149
    v_rcp_f32 v150, v150
    v_rcp_f32 v151, v151
    v_rcp_f32 v152, v152
    v_rcp_f32 v153, v153
    v_rcp_f32 v154, v154
    v_rcp_f32 v155, v155
    v_rcp_f32 v156, v156
    v_rcp_f32 v157, v157
    v_rcp_f32 v158, v158
    v_rcp_f32 v159, v159
    v_mul_f32 v144, v144, v112
    v_mul_f32 v145, v145, v113
    v_mul_f32 v146, v146, v114
    v_mul_f32 v147, v147, v115
    v_mul_f32 v148, v148, v116
    v_mul_f32 v149, v149, v117
    v_mul_f32 v150, v150, v118
    v_mul_f32 v151, v151, v119
    v_mul_f32 v152, v152, v120
    v_mul_f32 v153, v153, v121
    v_mul_f32 v154, v154, v122
    v_mul_f32 v155, v155, v123
    v_mul_f32 v156, v156, v124
    v_mul_f32 v157, v157, v125
    v_mul_f32 v158, v158, v126
    v_mul_f32 v159, v159, v127
    s_cmp_lt_u32 s4, 3
    s_cbranch_scc1 LHo3
    s_mov_b32 s61, 0
Lfw71:
    ds_read_b128 v[12:15], v5 offset:32
    s_add_u32 s61, s61, 1
    s_waitcnt lgkmcnt(0)
    v_min3_u32 v12, v12, v13, v14
    v_min_u32 v12, v12, v15
    v_cmp_eq_u32 vcc, 0, v12
    s_cmp_ge_u32 s61, 4194304
    s_cbranch_scc1 Lfd72
    s_cbranch_vccnz Lfw71
Lfd72:
    ds_read_b128 v[96:99], v8 offset:0
    ds_read_b128 v[100:103], v8 offset:32736
    ds_read_b128 v[104:107], v60 offset:0
    ds_read_b128 v[108:111], v60 offset:32736
    s_waitcnt lgkmcnt(3)
    v_fmac_f32 v64, v96, v128
    v_fmac_f32 v65, v97, v129
    v_fmac_f32 v66, v98, v130
    v_fmac_f32 v67, v99, v131
    s_waitcnt lgkmcnt(2)
    v_fmac_f32 v68, v100, v132
    v_fmac_f32 v69, v101, v133
    v_fmac_f32 v70, v102, v134
    v_fmac_f32 v71, v103, v135
    s_waitcnt lgkmcnt(1)
    v_fmac_f32 v72, v104, v136
    v_fmac_f32 v73, v105, v137
    v_fmac_f32 v74, v106, v138
    v_fmac_f32 v75, v107, v139
    s_waitcnt lgkmcnt(0)
    v_fmac_f32 v76, v108, v140
    v_fmac_f32 v77, v109, v141
    v_fmac_f32 v78, v110, v142
    v_fmac_f32 v79, v111, v143
    v_cvt_pk_bf16_f32 v36, v64, v68
    v_cvt_pk_bf16_f32 v37, v72, v76
    buffer_store_dwordx2 v[36:37], v2, s[52:55], s3 offen offset:0
    v_cvt_pk_bf16_f32 v38, v65, v69
    v_cvt_pk_bf16_f32 v39, v73, v77
    buffer_store_dwordx2 v[38:39], v2, s[52:55], s3 offen offset:1280
    v_cvt_pk_bf16_f32 v40, v66, v70
    v_cvt_pk_bf16_f32 v41, v74, v78
    buffer_store_dwordx2 v[40:41], v2, s[52:55], s3 offen offset:2560
    v_cvt_pk_bf16_f32 v42, v67, v71
    v_cvt_pk_bf16_f32 v43, v75, v79
    buffer_store_dwordx2 v[42:43], v2, s[52:55], s3 offen offset:3840
LHo3:
    s_mov_b32 s61, 0
Lfw73:
    ds_read_b128 v[12:15], v5 offset:96
    s_add_u32 s61, s61, 1
    s_waitcnt lgkmcnt(0)
    v_min3_u32 v12, v12, v13, v14
    v_min_u32 v12, v12, v15
    v_cmp_eq_u32 vcc, 0, v12
    s_cmp_ge_u32 s61, 4194304
    s_cbranch_scc1 Lfd74
    s_cbranch_vccnz Lfw73
Lfd74:
    ds_read_b128 v[112:115], v8 offset:4096
    ds_read_b128 v[116:119], v8 offset:36832
    ds_read_b128 v[120:123], v60 offset:4096
    ds_read_b128 v[124:127], v60 offset:36832
    s_waitcnt lgkmcnt(3)
    v_fmac_f32 v80, v112, v144
    v_fmac_f32 v81, v113, v145
    v_fmac_f32 v82, v114, v146
    v_fmac_f32 v83, v115, v147
    s_waitcnt lgkmcnt(2)
    v_fmac_f32 v84, v116, v148
    v_fmac_f32 v85, v117, v149
    v_fmac_f32 v86, v118, v150
    v_fmac_f32 v87, v119, v151
    s_waitcnt lgkmcnt(1)
    v_fmac_f32 v88, v120, v152
    v_fmac_f32 v89, v121, v153
    v_fmac_f32 v90, v122, v154
    v_fmac_f32 v91, v123, v155
    s_waitcnt lgkmcnt(0)
    v_fmac_f32 v92, v124, v156
    v_fmac_f32 v93, v125, v157
    v_fmac_f32 v94, v126, v158
    v_fmac_f32 v95, v127, v159
    v_cvt_pk_bf16_f32 v44, v80, v84
    v_cvt_pk_bf16_f32 v45, v88, v92
    buffer_store_dwordx2 v[44:45], v3, s[52:55], s3 offen offset:0
    v_cvt_pk_bf16_f32 v46, v81, v85
    v_cvt_pk_bf16_f32 v47, v89, v93
    buffer_store_dwordx2 v[46:47], v3, s[52:55], s3 offen offset:1280
    v_cvt_pk_bf16_f32 v48, v82, v86
    v_cvt_pk_bf16_f32 v49, v90, v94
    buffer_store_dwordx2 v[48:49], v3, s[52:55], s3 offen offset:2560
    v_cvt_pk_bf16_f32 v50, v83, v87
    v_cvt_pk_bf16_f32 v51, v91, v95
    buffer_store_dwordx2 v[50:51], v3, s[52:55], s3 offen offset:3840
    s_cmp_lg_u32 s4, 1
    s_cbranch_scc1 LHg3
    v_lshlrev_b32 v244, 4, v1
    v_add_u32 v245, 4096, v244
    v_min_u32 v246, 55, v1
    v_lshlrev_b32 v246, 4, v246
    v_add_u32 v247, 6144, v246
    s_mul_i32 s59, s46, 7040
    s_add_u32 s59, s59, 45056
    s_mov_b32 s61, 0
    s_mov_b32 s62, 0x04000c0c
    s_mov_b32 s63, 0x0706000c
LHg:
    buffer_load_dwordx4 v[160:163], v244, s[8:11], s59 offen offset:0 sc1
    buffer_load_dwordx4 v[164:167], v244, s[8:11], s59 offen offset:1024 sc1
    buffer_load_dwordx4 v[168:171], v244, s[8:11], s59 offen offset:2048 sc1
    buffer_load_dwordx4 v[172:175], v244, s[8:11], s59 offen offset:3072 sc1
    buffer_load_dwordx4 v[176:179], v245, s[8:11], s59 offen offset:0 sc1
    buffer_load_dwordx4 v[180:183], v245, s[8:11], s59 offen offset:1024 sc1
    buffer_load_dwordx4 v[184:187], v247, s[8:11], s59 offen offset:0 sc1
    s_add_u32 s61, s61, 1
    s_waitcnt vmcnt(0)
LHg2:
    v_xor_b32 v20, s5, v163
    v_xor_b32 v21, s5, v167
    v_xor_b32 v22, s5, v171
    v_xor_b32 v23, s5, v175
    v_xor_b32 v24, s5, v179
    v_xor_b32 v25, s5, v183
    v_xor_b32 v26, s5, v187
    v_or3_b32 v20, v20, v21, v22
    v_or3_b32 v23, v23, v24, v25
    v_or3_b32 v20, v20, v23, v26
    v_cmp_ne_u32 vcc, 0, v20
    s_cmp_ge_u32 s61, 4194304
    s_cbranch_scc1 LHg1
    s_and_b64 exec, exec, vcc
    s_cbranch_execz LHg1
    s_branch LHg
LHg1:
    s_mov_b32 exec_lo, 0
    s_mov_b32 exec_hi, 0xffff0000
    v_add_u32 v246, 150944, v246
    ds_write_b128 v246, v[184:187]
    ds_write_b32 v9, v9 offset:176
    v_mov_b32 v184, 0
    v_mov_b32 v185, 0
    v_mov_b32 v186, 0
    s_mov_b64 exec, -1
    v_perm_b32 v163, v162, v161, s62
    v_perm_b32 v163, v163, v160, s63
    v_perm_b32 v167, v166, v165, s62
    v_perm_b32 v167, v167, v164, s63
    v_perm_b32 v171, v170, v169, s62
    v_perm_b32 v171, v171, v168, s63
    v_perm_b32 v175, v174, v173, s62
    v_perm_b32 v175, v175, v172, s63
    v_perm_b32 v179, v178, v177, s62
    v_perm_b32 v179, v179, v176, s63
    v_perm_b32 v183, v182, v181, s62
    v_perm_b32 v183, v183, v180, s63
    v_perm_b32 v187, v186, v185, s62
    v_perm_b32 v187, v187, v184, s63
    v_pk_add_f32 v[160:161], v[160:161], v[164:165]
    v_pk_add_f32 v[162:163], v[162:163], v[166:167]
    v_pk_add_f32 v[168:169], v[168:169], v[172:173]
    v_pk_add_f32 v[170:171], v[170:171], v[174:175]
    v_pk_add_f32 v[176:177], v[176:177], v[180:181]
    v_pk_add_f32 v[178:179], v[178:179], v[182:183]
    v_pk_add_f32 v[160:161], v[160:161], v[168:169]
    v_pk_add_f32 v[162:163], v[162:163], v[170:171]
    v_pk_add_f32 v[176:177], v[176:177], v[184:185]
    v_pk_add_f32 v[178:179], v[178:179], v[186:187]
    v_pk_add_f32 v[160:161], v[160:161], v[176:177]
    v_pk_add_f32 v[162:163], v[162:163], v[178:179]
    s_nop 1
    v_permlane32_swap_b32 v160, v162
    v_permlane32_swap_b32 v161, v163
    v_add_f32 v160, v160, v162
    v_add_f32 v161, v161, v163
    s_nop 1
    v_permlane16_swap_b32 v160, v161
    v_add_f32 v160, v160, v161
    s_nop 1
    v_add_f32_dpp v160, v160, v160 row_ror:8 row_mask:0xf bank_mask:0xf
    ds_write_b32 v234, v160
    ds_write_b32 v9, v9 offset:160
LHg3:
    s_mov_b32 s61, 0
Lfw75:
    ds_read_b32 v12, v9 offset:176
    s_add_u32 s61, s61, 1
    s_waitcnt lgkmcnt(0)
    v_cmp_eq_u32 vcc, 0, v12
    s_cmp_ge_u32 s61, 4194304
    s_cbranch_scc1 Lfd76
    s_cbranch_vccnz Lfw75
Lfd76:
    ds_read_b32 v20, v231 offset:8
    ds_read_u16 v21, v235
    s_waitcnt lgkmcnt(1)
    v_not_b32 v34, v20
    v_and_b32 v22, 0x7ff, v34
    v_bfe_u32 v13, v22, 8, 2
    v_cmp_eq_u32 vcc, s4, v13
    s_nop 0
    s_and_b64 exec, exec, vcc
    s_cbranch_execz Lfin
    v_lshl_add_u32 v232, v22, 1, v232
    ds_read_u16 v32, v232
    v_bfe_u32 v13, v22, 5, 2
    v_lshlrev_b32 v13, 2, v13
    v_xor_b32 v13, v13, v22
    v_lshl_add_u32 v233, v13, 2, v233
    ds_read_b32 v33, v233
    v_mul_u32_u24 v23, 1280, v22
    v_lshl_add_u32 v23, v230, 1, v23
    v_ashrrev_i32 v34, 31, v34
    v_or_b32 v34, 0x80000000, v34
    v_xor_b32 v34, v34, v20
    v_and_b32 v34, 0xffff0000, v34
    v_mul_f32 v34, s30, v34
    v_exp_f32 v34, v34
    s_nop 0
    v_add_f32 v34, 1.0, v34
    v_rcp_f32 v34, v34
    s_waitcnt lgkmcnt(0)
    v_lshlrev_b32 v32, 16, v32
    v_lshlrev_b32 v21, 16, v21
    s_mov_b32 s61, 0
LHr:
    ds_read_b32 v12, v9 offset:160
    ds_read_b32 v28, v234
    s_add_u32 s61, s61, 1
    s_waitcnt lgkmcnt(0)
    v_cmp_eq_u32 vcc, 0, v12
    s_cmp_ge_u32 s61, 4194304
    s_cbranch_scc1 LHs
    s_cbranch_vccnz LHr
LHs:
    v_fma_f32 v28, v28, v34, v32
    v_mul_f32 v29, s30, v28
    v_exp_f32 v29, v29
    v_mul_f32 v33, v33, v28
    v_add_f32 v29, 1.0, v29
    v_rcp_f32 v29, v29
    s_nop 0
    v_fma_f32 v33, v33, v29, v21
    v_cvt_pk_bf16_f32 v33, v33, v33
    buffer_store_short v33, v23, s[52:55], s3 offen
    s_branch Lfin
LLL:
    s_mov_b32 s60, 0xa0a0404
    s_mov_b32 s61, 0xa080404
    s_lshr_b64 s[60:61], s[60:61], s62
    s_and_b32 s64, s60, 0xff
    s_mov_b32 s60, 0x3a302c28
    s_mov_b32 s61, 0x544c4844
    s_lshr_b64 s[60:61], s[60:61], s62
    s_and_b32 s66, s60, 0xff
    s_mov_b32 s60, 0xe080400
    s_mov_b32 s61, 0x241c1814
    s_lshr_b64 s[60:61], s[60:61], s62
    s_and_b32 s67, s60, 0xff
    s_sub_u32 s49, s63, s64
    s_mov_b32 s60, 0x9040200
    s_mov_b32 s61, 0x1612100e
    s_lshr_b64 s[60:61], s[60:61], s62
    s_and_b32 s68, s60, 0xff
    s_mov_b32 s60, 0x5050202
    s_mov_b32 s61, 0x5040202
    s_lshr_b64 s[60:61], s[60:61], s62
    s_and_b32 s69, s60, 0xff
    s_mov_b32 s60, 0x6060404
    s_mov_b32 s61, 0x6080404
    s_lshr_b64 s[60:61], s[60:61], s62
    s_and_b32 s65, s60, 0xff
    s_add_u32 s67, s67, s63
    s_sub_u32 s67, s67, s64
    s_add_u32 s2, s67, 54
    s_cmp_lt_u32 s67, 40
    s_cselect_b32 s2, s67, s2
    s_add_u32 s66, s66, s63
    s_cmp_lt_u32 s63, s64
    s_cselect_b32 s2, s66, s2
Lmapd:
    v_and_b32 v1, 63, v0
    s_mov_b32 s14, 2621440
    s_mov_b32 s15, 0x00020000
    s_mov_b32 s10, 16777216
    s_mov_b32 s11, 0x00020000
    s_cmp_ge_u32 s2, 96
    s_cbranch_scc1 LCONV
    v_lshlrev_b32 v2, 4, v1
    v_lshlrev_b32 v9, 2, v1
    v_add_u32 v3, 1024, v9
    s_mov_b32 s60, 0x202
    s_mov_b32 s61, 0x30202
    s_lshr_b64 s[60:61], s[60:61], s62
    s_and_b32 s57, s60, 0xff
    s_mov_b32 s60, 0xa4a4a2a0
    s_mov_b32 s61, 0xaba8a6a4
    s_lshr_b64 s[60:61], s[60:61], s62
    s_and_b32 s58, s60, 0xff
    s_add_u32 s58, s58, s49
    s_cmp_lt_u32 s49, s57
    s_cselect_b32 s58, s58, 255
    s_mul_i32 s46, s58, 12
    s_mul_i32 s7, s4, 3
    s_add_u32 s46, s46, s7
    s_mul_i32 s6, s46, 1280
    s_sub_u32 s47, s2, 40
    s_mov_b32 s59, s49
    v_mov_b32 v8, 0
    ds_write_b32 v9, v8 offset:40960
    ds_write_b32 v9, v8 offset:1024
    ds_write_b32 v9, v8 offset:0
    v_lshrrev_b32 v4, 4, v1
    s_waitcnt lgkmcnt(0)
    s_mov_b32 s12, s16
    s_mov_b32 s13, s17
    s_mov_b32 s8, s44
    s_mov_b32 s9, s45
    s_barrier
    s_cmp_ge_u32 s47, 54
    s_cbranch_scc1 LSP
    s_cmp_ge_u32 s4, 5
    s_cbranch_scc1 LFC
    s_mov_b32 s58, s71
    s_mov_b32 s52, s38
    s_mov_b32 s53, s39
    s_mov_b32 s54, 2211840
    s_mov_b32 s55, 0x00020000
    v_mul_u32_u24 v84, 2560, v4
    v_and_b32 v6, 15, v1
    v_lshl_add_u32 v84, v6, 4, v84
    s_mul_i32 s48, s47, 40960
    s_lshl_b32 s61, s4, 8
    s_add_u32 s48, s48, s61
    s_add_u32 s49, s48, 10240
    s_add_u32 s50, s48, 20480
    s_add_u32 s51, s48, 30720
    s_mov_b32 s56, 10368
    s_mov_b32 s57, 0
    s_and_b32 s70, s47, 1
    v_bfe_u32 v5, v1, 3, 1
    v_lshl_add_u32 v5, v5, 2, v4
    v_mul_u32_u24 v5, 27648, v5
    v_and_b32 v6, 3, v1
    v_lshl_add_u32 v5, v6, 4, v5
    s_mul_i32 s60, s4, 442368
    s_lshl_b32 s61, s47, 6
    s_add_u32 s60, s60, s61
    s_add_u32 s60, s60, 3456
    s_mul_i32 s61, s70, 221184
    s_sub_u32 s62, 221184, s61
    s_add_u32 s61, s61, s60
    s_add_u32 s62, s62, s60
    v_and_b32 v6, 4, v1
    v_cmp_ne_u32 vcc, 0, v6
    v_mov_b32 v6, s34
    v_mov_b32 v7, s36
    v_cndmask_b32 v6, v6, v7, vcc
    v_mov_b32 v7, s35
    v_mov_b32 v8, s37
    v_cndmask_b32 v7, v7, v8, vcc
    v_add_u32 v40, s61, v5
    v_mov_b32 v41, 0
    v_add_u32 v46, s62, v5
    v_mov_b32 v47, 0
    v_lshl_add_u64 v[40:41], v[40:41], 0, v[6:7]
    v_lshl_add_u64 v[42:43], v[40:41], 0, s[56:57]
    v_lshl_add_u64 v[44:45], v[42:43], 0, s[56:57]
    v_lshl_add_u64 v[46:47], v[46:47], 0, v[6:7]
    v_lshl_add_u64 v[48:49], v[46:47], 0, s[56:57]
    v_lshl_add_u64 v[50:51], v[48:49], 0, s[56:57]
    buffer_load_dwordx4 v[192:195], v84, s[52:55], s48 offen offset:0 nt
    buffer_load_dwordx4 v[196:199], v84, s[52:55], s49 offen offset:0 nt
    buffer_load_dwordx4 v[200:203], v84, s[52:55], s50 offen offset:0 nt
    buffer_load_dwordx4 v[204:207], v84, s[52:55], s51 offen offset:0 nt
    buffer_load_dwordx4 v[208:211], v84, s[52:55], s48 offen offset:1280 nt
    buffer_load_dwordx4 v[212:215], v84, s[52:55], s49 offen offset:1280 nt
    buffer_load_dwordx4 v[216:219], v84, s[52:55], s50 offen offset:1280 nt
    buffer_load_dwordx4 v[220:223], v84, s[52:55], s51 offen offset:1280 nt
    v_and_b32 v10, 7, v1
    v_bfe_u32 v12, v1, 3, 1
    s_mul_i32 s60, s4, 2176
    s_add_u32 s60, s60, 2048
    v_and_b32 v16, 15, v1
    v_lshlrev_b32 v16, 4, v16
    v_mul_u32_u24 v37, 272, v4
    v_add3_u32 v37, v37, v16, s60
    v_mul_u32_u24 v11, 272, v10
    v_lshl_add_u32 v11, v12, 6, v11
    v_lshl_add_u32 v11, v4, 4, v11
    s_lshl_b32 s61, s70, 7
    s_add_u32 s60, s60, s61
    v_add_u32 v11, s60, v11
    s_lshl_b32 s61, s70, 8
    s_sub_u32 s61, 128, s61
    v_add_u32 v38, s61, v11
    s_lshl_b32 s66, s4, 8
    v_lshlrev_b32 v18, 2, v10
    v_lshlrev_b32 v39, 2, v4
    s_mul_i32 s60, s4, 1280
    v_mul_u32_u24 v13, 144, v10
    v_lshl_add_u32 v13, v12, 4, v13
    v_lshrrev_b32 v14, 5, v1
    v_lshl_add_u32 v13, v14, 6, v13
    v_and_b32 v14, 1, v4
    v_mul_u32_u24 v14, 6400, v14
    v_add3_u32 v13, v13, v14, s60
    s_mov_b32 s64, 0x00ff00ff
    s_mov_b32 s65, 0x00ff00ff
    v_mov_b32 v88, 0
    v_mov_b32 v89, 0
    v_mov_b32 v90, 0
    v_mov_b32 v91, 0
    v_mov_b32 v92, 0
    v_mov_b32 v93, 0
    v_mov_b32 v94, 0
    v_mov_b32 v95, 0
    v_lshl_add_u32 v15, v4, 3, v12
    v_mul_u32_u24 v15, 7040, v15
    v_lshl_add_u32 v15, v10, 4, v15
    v_mul_u32_u24 v17, 80, v10
    v_lshl_add_u32 v17, v4, 4, v17
    v_lshrrev_b32 v7, 5, v0
    v_and_b32 v8, 31, v0
    v_mul_u32_u24 v9, 144, v7
    v_lshl_add_u32 v9, v8, 2, v9
    v_add_u32 v9, 13312, v9
    v_lshlrev_b32 v5, 2, v7
    v_mul_u32_u24 v7, 80, v7
    v_lshl_add_u32 v7, v8, 1, v7
    s_mov_b32 s62, 0x05040100
    s_mov_b32 s63, 0x07060302
    v_mov_b32 v85, 0
    s_waitcnt vmcnt(2)
    global_load_dwordx4 v[128:131], v[40:41], off offset:-3456
    v_perm_b32 v224, v196, v192, s62
    v_perm_b32 v228, v196, v192, s63
    v_perm_b32 v232, v197, v193, s62
    v_perm_b32 v236, v197, v193, s63
    v_perm_b32 v240, v198, v194, s62
    v_perm_b32 v244, v198, v194, s63
    v_perm_b32 v248, v199, v195, s62
    v_perm_b32 v252, v199, v195, s63
    v_perm_b32 v225, v204, v200, s62
    v_perm_b32 v229, v204, v200, s63
    v_perm_b32 v233, v205, v201, s62
    v_perm_b32 v237, v205, v201, s63
    v_perm_b32 v241, v206, v202, s62
    v_perm_b32 v245, v206, v202, s63
    v_perm_b32 v249, v207, v203, s62
    v_perm_b32 v253, v207, v203, s63
    v_perm_b32 v226, v212, v208, s62
    v_perm_b32 v230, v212, v208, s63
    v_perm_b32 v234, v213, v209, s62
    v_perm_b32 v238, v213, v209, s63
    v_perm_b32 v242, v214, v210, s62
    v_perm_b32 v246, v214, v210, s63
    v_perm_b32 v250, v215, v211, s62
    v_perm_b32 v254, v215, v211, s63
    s_waitcnt vmcnt(2)
    global_load_dwordx4 v[132:135], v[40:41], off offset:0
    s_waitcnt vmcnt(2)
    global_load_dwordx4 v[136:139], v[40:41], off offset:3456
    v_perm_b32 v227, v220, v216, s62
    v_perm_b32 v231, v220, v216, s63
    v_perm_b32 v235, v221, v217, s62
    v_perm_b32 v239, v221, v217, s63
    v_perm_b32 v243, v222, v218, s62
    v_perm_b32 v247, v222, v218, s63
    v_perm_b32 v251, v223, v219, s62
    v_perm_b32 v255, v223, v219, s63
    s_waitcnt vmcnt(2)
    global_load_dwordx4 v[140:143], v[42:43], off offset:-3456
    s_waitcnt vmcnt(2)
    global_load_dwordx4 v[172:175], v[48:49], off offset:-3456
    v_perm_b32 v96, v132, v128, s62
    v_perm_b32 v100, v132, v128, s63
    v_perm_b32 v104, v133, v129, s62
    v_perm_b32 v108, v133, v129, s63
    v_perm_b32 v112, v134, v130, s62
    v_perm_b32 v116, v134, v130, s63
    v_perm_b32 v120, v135, v131, s62
    v_perm_b32 v124, v135, v131, s63
    s_waitcnt vmcnt(2)
    global_load_dwordx4 v[144:147], v[42:43], off offset:0
    s_waitcnt vmcnt(2)
    global_load_dwordx4 v[176:179], v[48:49], off offset:0
    v_perm_b32 v97, v140, v136, s62
    v_perm_b32 v101, v140, v136, s63
    v_perm_b32 v105, v141, v137, s62
    v_perm_b32 v109, v141, v137, s63
    v_perm_b32 v113, v142, v138, s62
    v_perm_b32 v117, v142, v138, s63
    v_perm_b32 v121, v143, v139, s62
    v_perm_b32 v125, v143, v139, s63
    s_waitcnt vmcnt(2)
    ds_write_b32 v85, v3 offset:1088
    s_waitcnt vmcnt(2)
    global_load_dwordx4 v[148:151], v[42:43], off offset:3456
    s_waitcnt vmcnt(2)
    global_load_dwordx4 v[180:183], v[48:49], off offset:3456
    s_waitcnt vmcnt(2)
    global_load_dwordx4 v[152:155], v[44:45], off offset:-3456
    global_load_dwordx4 v[184:187], v[50:51], off offset:-3456
    global_load_dwordx4 v[156:159], v[44:45], off offset:0
    global_load_dwordx4 v[188:191], v[50:51], off offset:0
    global_load_dwordx4 v[160:163], v[46:47], off offset:-3456
    global_load_dwordx4 v[164:167], v[46:47], off offset:0
    global_load_dwordx4 v[168:171], v[46:47], off offset:3456
    s_waitcnt vmcnt(8)
    v_perm_b32 v98, v148, v144, s62
    v_perm_b32 v102, v148, v144, s63
    v_perm_b32 v106, v149, v145, s62
    v_perm_b32 v110, v149, v145, s63
    v_perm_b32 v114, v150, v146, s62
    v_perm_b32 v118, v150, v146, s63
    v_perm_b32 v122, v151, v147, s62
    v_perm_b32 v126, v151, v147, s63
    s_waitcnt vmcnt(7)
    v_perm_b32 v194, v180, v176, s62
    v_perm_b32 v198, v180, v176, s63
    v_perm_b32 v202, v181, v177, s62
    v_perm_b32 v206, v181, v177, s63
    v_perm_b32 v210, v182, v178, s62
    v_perm_b32 v214, v182, v178, s63
    v_perm_b32 v218, v183, v179, s62
    v_perm_b32 v222, v183, v179, s63
    s_waitcnt vmcnt(4)
    v_perm_b32 v99, v156, v152, s62
    v_perm_b32 v103, v156, v152, s63
    v_perm_b32 v107, v157, v153, s62
    v_perm_b32 v111, v157, v153, s63
    v_perm_b32 v115, v158, v154, s62
    v_perm_b32 v119, v158, v154, s63
    v_perm_b32 v123, v159, v155, s62
    v_perm_b32 v127, v159, v155, s63
    s_mov_b32 s61, 0
LFWa:
    ds_read_b32 v19, v18 offset:1152
    ds_read_b32 v28, v39 offset:1152
    ds_read_b32 v29, v39 offset:1168
    ds_read_b32 v31, v85 offset:1096
    s_add_u32 s61, s61, 1
    s_waitcnt lgkmcnt(0)
    v_cmp_eq_u32 vcc, 0, v19
    s_cmp_ge_u32 s61, 4194304
    s_cbranch_scc1 LFWb
    s_cbranch_vccnz LFWa
LFWb:
    s_movk_i32 s60, 0x7ff
    s_movk_i32 s61, 1280
    v_bfi_b32 v28, v28, 0, s60
    v_mad_u32_u24 v28, v28, s61, v16
    buffer_load_dwordx4 v[20:23], v28, s[12:15], s66 offen
    v_bfi_b32 v29, v29, 0, s60
    v_mad_u32_u24 v29, v29, s61, v16
    buffer_load_dwordx4 v[24:27], v29, s[12:15], s66 offen
    v_bfi_b32 v19, v19, 0, s60
    v_mul_u32_u24 v29, 43691, v19
    v_lshrrev_b32 v29, 19, v29
    v_lshrrev_b32 v30, 1, v19
    v_lshl_add_u32 v29, v29, 1, v30
    v_lshlrev_b32 v29, 4, v29
    v_and_b32 v30, 1, v19
    s_movk_i32 s60, 4096
    s_mov_b32 s61, 0
    s_mov_b64 exec, 0xff
    buffer_load_dwordx4 v[32:35], v29, s[8:11], s60 offen sc1
    s_mov_b64 exec, -1
    v_readfirstlane_b32 s5, v31
    v_cmp_eq_u32 s[16:17], 1, v30
    v_lshlrev_b32 v30, 4, v30
    s_waitcnt vmcnt(6)
    v_perm_b32 v195, v188, v184, s62
    v_perm_b32 v199, v188, v184, s63
    v_perm_b32 v203, v189, v185, s62
    v_perm_b32 v207, v189, v185, s63
    v_perm_b32 v211, v190, v186, s62
    v_perm_b32 v215, v190, v186, s63
    v_perm_b32 v219, v191, v187, s62
    v_perm_b32 v223, v191, v187, s63
    s_waitcnt vmcnt(4)
    v_perm_b32 v192, v164, v160, s62
    v_perm_b32 v196, v164, v160, s63
    v_perm_b32 v200, v165, v161, s62
    v_perm_b32 v204, v165, v161, s63
    v_perm_b32 v208, v166, v162, s62
    v_perm_b32 v212, v166, v162, s63
    v_perm_b32 v216, v167, v163, s62
    v_perm_b32 v220, v167, v163, s63
    s_waitcnt vmcnt(3)
    v_perm_b32 v193, v172, v168, s62
    v_perm_b32 v197, v172, v168, s63
    v_perm_b32 v201, v173, v169, s62
    v_perm_b32 v205, v173, v169, s63
    v_perm_b32 v209, v174, v170, s62
    v_perm_b32 v213, v174, v170, s63
    v_perm_b32 v217, v175, v171, s62
    v_perm_b32 v221, v175, v171, s63
    s_waitcnt vmcnt(2)
    ds_write_b128 v37, v[20:23]
    s_waitcnt vmcnt(1)
    ds_write_b128 v37, v[24:27] offset:1088
    ds_read_b128 v[20:23], v11
    ds_read_b128 v[24:27], v38
    s_mov_b64 exec, 0xff
    s_branch LFWs1
LFWs:
    buffer_load_dwordx4 v[32:35], v29, s[8:11], s60 offen sc1
LFWs1:
    s_add_u32 s61, s61, 1
    s_waitcnt vmcnt(0)
    v_cmp_ne_u32 vcc, s5, v35
    s_cmp_ge_u32 s61, 4194304
    s_cbranch_scc1 LFWt
    s_cbranch_vccnz LFWs
LFWt:
    v_lshrrev_b32 v34, v30, v34
    v_cndmask_b32 v32, v32, v33, s[16:17]
    ds_write2_b32 v18, v32, v34 offset0:224 offset1:240
    s_mov_b64 exec, -1
    ds_read_u16 v32, v18 offset:960
    s_waitcnt lgkmcnt(2)
    v_lshlrev_b32 v72, 16, v20
    v_and_b32 v73, 0xffff0000, v20
    v_lshlrev_b32 v74, 16, v21
    v_and_b32 v75, 0xffff0000, v21
    v_lshlrev_b32 v76, 16, v22
    v_and_b32 v77, 0xffff0000, v22
    v_lshlrev_b32 v78, 16, v23
    v_and_b32 v79, 0xffff0000, v23
    s_waitcnt lgkmcnt(0)
    v_lshlrev_b32 v32, 16, v32
    v_pk_add_f32 v[72:73], v[72:73], v[32:33] op_sel_hi:[1,0] neg_lo:[0,1] neg_hi:[0,1]
    v_pk_add_f32 v[74:75], v[74:75], v[32:33] op_sel_hi:[1,0] neg_lo:[0,1] neg_hi:[0,1]
    v_pk_add_f32 v[76:77], v[76:77], v[32:33] op_sel_hi:[1,0] neg_lo:[0,1] neg_hi:[0,1]
    v_pk_add_f32 v[78:79], v[78:79], v[32:33] op_sel_hi:[1,0] neg_lo:[0,1] neg_hi:[0,1]
    v_cvt_pk_bf16_f32 v20, v72, v73
    v_cvt_pk_bf16_f32 v21, v74, v75
    v_cvt_pk_bf16_f32 v22, v76, v77
    v_cvt_pk_bf16_f32 v23, v78, v79
    s_nop 1
    v_mfma_f32_16x16x32_bf16 v[40:43], v[96:99], v[20:23], 0
    v_lshlrev_b32 v72, 16, v24
    v_and_b32 v73, 0xffff0000, v24
    v_mfma_f32_16x16x32_bf16 v[56:59], v[112:115], v[20:23], 0
    v_lshlrev_b32 v74, 16, v25
    v_and_b32 v75, 0xffff0000, v25
    v_mfma_f32_16x16x32_bf16 v[44:47], v[100:103], v[20:23], 0
    v_lshlrev_b32 v76, 16, v26
    v_and_b32 v77, 0xffff0000, v26
    v_mfma_f32_16x16x32_bf16 v[60:63], v[116:119], v[20:23], 0
    v_lshlrev_b32 v78, 16, v27
    v_and_b32 v79, 0xffff0000, v27
    v_mfma_f32_16x16x32_bf16 v[48:51], v[104:107], v[20:23], 0
    v_pk_add_f32 v[72:73], v[72:73], v[32:33] op_sel_hi:[1,0] neg_lo:[0,1] neg_hi:[0,1]
    v_pk_add_f32 v[74:75], v[74:75], v[32:33] op_sel_hi:[1,0] neg_lo:[0,1] neg_hi:[0,1]
    v_mfma_f32_16x16x32_bf16 v[64:67], v[120:123], v[20:23], 0
    v_pk_add_f32 v[76:77], v[76:77], v[32:33] op_sel_hi:[1,0] neg_lo:[0,1] neg_hi:[0,1]
    v_pk_add_f32 v[78:79], v[78:79], v[32:33] op_sel_hi:[1,0] neg_lo:[0,1] neg_hi:[0,1]
    v_mfma_f32_16x16x32_bf16 v[52:55], v[108:111], v[20:23], 0
    v_cvt_pk_bf16_f32 v24, v72, v73
    v_cvt_pk_bf16_f32 v25, v74, v75
    v_mfma_f32_16x16x32_bf16 v[68:71], v[124:127], v[20:23], 0
    v_cvt_pk_bf16_f32 v26, v76, v77
    v_cvt_pk_bf16_f32 v27, v78, v79
    ds_read_b32 v6, v5 offset:896
    s_nop 0
    v_mfma_f32_16x16x32_bf16 v[40:43], v[192:195], v[24:27], v[40:43]
    v_mfma_f32_16x16x32_bf16 v[56:59], v[208:211], v[24:27], v[56:59]
    v_mfma_f32_16x16x32_bf16 v[44:47], v[196:199], v[24:27], v[44:47]
    v_mfma_f32_16x16x32_bf16 v[60:63], v[212:215], v[24:27], v[60:63]
    v_mfma_f32_16x16x32_bf16 v[48:51], v[200:203], v[24:27], v[48:51]
    v_mfma_f32_16x16x32_bf16 v[64:67], v[216:219], v[24:27], v[64:67]
    v_mfma_f32_16x16x32_bf16 v[52:55], v[204:207], v[24:27], v[52:55]
    v_mfma_f32_16x16x32_bf16 v[68:71], v[220:223], v[24:27], v[68:71]
    s_mov_b32 s60, 3216550459
    s_nop 0
    v_permlane32_swap_b32 v40, v56
    v_permlane32_swap_b32 v41, v57
    v_permlane32_swap_b32 v42, v58
    v_permlane32_swap_b32 v43, v59
    v_permlane32_swap_b32 v44, v60
    v_permlane32_swap_b32 v45, v61
    v_permlane32_swap_b32 v46, v62
    v_permlane32_swap_b32 v47, v63
    v_add_f32_dpp v40, v56, v40 row_ror:8 row_mask:0xf bank_mask:0x3
    v_add_f32_dpp v41, v57, v41 row_ror:8 row_mask:0xf bank_mask:0x3
    v_add_f32_dpp v42, v58, v42 row_ror:8 row_mask:0xf bank_mask:0x3
    v_add_f32_dpp v43, v59, v43 row_ror:8 row_mask:0xf bank_mask:0x3
    v_add_f32_dpp v40, v44, v60 row_ror:8 row_mask:0xf bank_mask:0xc
    v_add_f32_dpp v41, v45, v61 row_ror:8 row_mask:0xf bank_mask:0xc
    v_add_f32_dpp v42, v46, v62 row_ror:8 row_mask:0xf bank_mask:0xc
    v_add_f32_dpp v43, v47, v63 row_ror:8 row_mask:0xf bank_mask:0xc
    ds_write_b128 v13, v[40:43] offset:13312
    v_permlane32_swap_b32 v48, v64
    v_permlane32_swap_b32 v49, v65
    v_permlane32_swap_b32 v50, v66
    v_permlane32_swap_b32 v51, v67
    v_permlane32_swap_b32 v52, v68
    v_permlane32_swap_b32 v53, v69
    v_permlane32_swap_b32 v54, v70
    v_permlane32_swap_b32 v55, v71
    v_add_f32_dpp v48, v64, v48 row_ror:8 row_mask:0xf bank_mask:0x3
    v_add_f32_dpp v49, v65, v49 row_ror:8 row_mask:0xf bank_mask:0x3
    v_add_f32_dpp v50, v66, v50 row_ror:8 row_mask:0xf bank_mask:0x3
    v_add_f32_dpp v51, v67, v51 row_ror:8 row_mask:0xf bank_mask:0x3
    v_add_f32_dpp v48, v52, v68 row_ror:8 row_mask:0xf bank_mask:0xc
    v_add_f32_dpp v49, v53, v69 row_ror:8 row_mask:0xf bank_mask:0xc
    v_add_f32_dpp v50, v54, v70 row_ror:8 row_mask:0xf bank_mask:0xc
    v_add_f32_dpp v51, v55, v71 row_ror:8 row_mask:0xf bank_mask:0xc
    ds_write_b128 v13, v[48:51] offset:13344
    s_waitcnt lgkmcnt(0)
    s_barrier
    s_cmp_eq_u32 s4, 4
    s_cbranch_scc1 LFWh
    ds_read2st64_b32 v[20:21], v9 offset0:0 offset1:25
    ds_read2st64_b32 v[22:23], v9 offset0:5 offset1:30
    ds_read2st64_b32 v[24:25], v9 offset0:10 offset1:35
    ds_read2st64_b32 v[26:27], v9 offset0:15 offset1:40
    ds_read2st64_b32 v[28:29], v9 offset0:20 offset1:45
    s_waitcnt lgkmcnt(1)
    v_pk_add_f32 v[20:21], v[20:21], v[22:23]
    v_pk_add_f32 v[24:25], v[24:25], v[26:27]
    v_pk_add_f32 v[20:21], v[20:21], v[24:25]
    s_waitcnt lgkmcnt(0)
    v_pk_add_f32 v[20:21], v[20:21], v[28:29]
    v_pk_mul_f32 v[20:21], v[20:21], v[6:7] op_sel_hi:[1,0]
    v_mul_f32 v35, s60, v20
    v_exp_f32 v35, v35
    v_mul_f32 v20, v20, v21
    v_add_f32 v35, 1.0, v35
    v_rcp_f32 v35, v35
    s_nop 0
    v_mul_f32 v35, v20, v35
    v_cvt_pk_bf16_f32 v35, v35, v35
    ds_write_b16 v7, v35 offset:38912
LFWh:
    s_mov_b32 s62, 0x07060501
    s_mov_b32 s63, 0x07060502
    s_mov_b32 s66, 0x07060503
    s_mul_i32 s60, s4, 225280
    s_lshl_b32 s61, s47, 7
    s_add_u32 s60, s60, s61
    s_add_u32 s60, s60, 45056
    v_mov_b32 v63, s5
    v_mov_b32 v67, s5
    v_mov_b32 v71, s5
    v_mov_b32 v75, s5
    s_waitcnt lgkmcnt(0)
    s_barrier
    s_mov_b64 exec, s[64:65]
    ds_read_b128 v[88:91], v17 offset:38912
    s_not_b64 exec, s[64:65]
    ds_read_b128 v[92:95], v17 offset:38912
    s_mov_b64 exec, -1
    s_waitcnt lgkmcnt(1)
    v_mfma_f32_16x16x32_bf16 v[52:55], v[236:239], v[88:91], 0
    v_mfma_f32_16x16x32_bf16 v[40:43], v[224:227], v[88:91], 0
    v_mfma_f32_16x16x32_bf16 v[44:47], v[228:231], v[88:91], 0
    v_mfma_f32_16x16x32_bf16 v[48:51], v[232:235], v[88:91], 0
    s_waitcnt lgkmcnt(0)
    v_mfma_f32_16x16x32_bf16 v[52:55], v[252:255], v[92:95], v[52:55]
    v_mfma_f32_16x16x32_bf16 v[40:43], v[240:243], v[92:95], v[40:43]
    v_mfma_f32_16x16x32_bf16 v[44:47], v[244:247], v[92:95], v[44:47]
    v_mfma_f32_16x16x32_bf16 v[48:51], v[248:251], v[92:95], v[48:51]
    s_nop 5
    v_perm_b32 v60, v40, v52, s62
    v_perm_b32 v61, v44, v52, s63
    v_perm_b32 v62, v48, v52, s66
    buffer_store_dwordx4 v[60:63], v15, s[8:11], s60 offen sc1
    s_add_u32 s60, s60, 14080
    v_perm_b32 v64, v41, v53, s62
    v_perm_b32 v65, v45, v53, s63
    v_perm_b32 v66, v49, v53, s66
    buffer_store_dwordx4 v[64:67], v15, s[8:11], s60 offen sc1
    s_add_u32 s60, s60, 14080
    v_perm_b32 v68, v42, v54, s62
    v_perm_b32 v69, v46, v54, s63
    v_perm_b32 v70, v50, v54, s66
    buffer_store_dwordx4 v[68:71], v15, s[8:11], s60 offen sc1
    s_add_u32 s60, s60, 14080
    v_perm_b32 v72, v43, v55, s62
    v_perm_b32 v73, v47, v55, s63
    v_perm_b32 v74, v51, v55, s66
    buffer_store_dwordx4 v[72:75], v15, s[8:11], s60 offen sc1
    s_add_u32 s60, s60, 14080
    s_branch Lfin
LFC:
    s_cmp_lg_u32 s4, 5
    s_cbranch_scc1 Lfin
    s_load_dword s5, s[44:45], 0
    s_setprio 3
    v_lshlrev_b32 v4, 7, v1
    v_add_u32 v5, 8192, v4
    v_min_u32 v6, 42, v1
    v_lshlrev_b32 v6, 7, v6
    v_add_u32 v6, 16384, v6
    s_mov_b32 s64, -1
    s_mov_b32 s65, 2047
    v_lshrrev_b32 v54, 3, v4
    v_lshrrev_b32 v55, 3, v5
    v_lshrrev_b32 v56, 3, v6
    v_and_b32 v52, 31, v1
    v_lshlrev_b32 v52, 2, v52
    v_lshrrev_b32 v53, 5, v1
    v_lshlrev_b32 v53, 4, v53
    v_mov_b32 v10, 0
    s_mov_b32 s67, 0
    s_mov_b32 s66, 0
    s_waitcnt lgkmcnt(0)
    s_mul_i32 s5, s5, 0x9E3779B1
    s_add_u32 s5, s5, 0x3C6EF35F
    v_mov_b32 v7, s5
    ds_write_b32 v10, v7 offset:1096
    s_lshl_b32 s60, s47, 4
    s_add_u32 s60, s60, 28672
    s_mov_b64 exec, 1
    v_mov_b32 v48, 0
    v_mov_b32 v49, s5
    buffer_store_dword v49, v48, s[8:11], s60 offen sc1
    s_mov_b64 exec, -1
    s_mov_b32 s46, 0
    v_mov_b32 v57, 0
    v_mov_b32 v13, 0
    v_mov_b32 v14, 0
    v_mov_b32 v16, 0
    v_mov_b32 v17, 0
    v_mov_b32 v18, 0
    v_mov_b32 v20, 0
    v_mov_b32 v21, 0
    v_mov_b32 v22, 0
    v_and_b32 v12, 7, v1
    v_lshlrev_b32 v12, 7, v12
    v_min_u32 v12, 0x280, v12
    v_and_b32 v16, 7, v1
    v_add_u32 v12, v12, v1
    v_add_u32 v12, 64, v12
    s_branch LFCt0
LFCgo:
    s_mov_b32 s46, 1
    v_mov_b32 v57, 1
    s_mov_b32 s66, 0
    ds_write_b32 v9, v10 offset:40960
    s_mov_b32 s61, 0
Lfw1:
    ds_read_b32 v7, v10 offset:1088
    s_add_u32 s61, s61, 1
    s_waitcnt lgkmcnt(0)
    v_cmp_eq_u32 vcc, 0, v7
    s_cmp_ge_u32 s61, 4194304
    s_cbranch_scc1 Lfd2
    s_cbranch_vccnz Lfw1
Lfd2:
    s_mov_b32 s60, 40960
    s_mov_b32 s61, 0
Lkp3:
    buffer_load_dwordx4 v[12:15], v54, s[8:11], s60 offen sc1
    buffer_load_dwordx4 v[16:19], v55, s[8:11], s60 offen sc1
    buffer_load_dwordx4 v[20:23], v56, s[8:11], s60 offen sc1
    s_add_u32 s61, s61, 1
    s_waitcnt vmcnt(0)
    v_xor_b32 v7, s5, v15
    v_xor_b32 v8, s5, v19
    v_xor_b32 v11, s5, v23
    v_or3_b32 v7, v7, v8, v11
    v_cmp_ne_u32 vcc, 0, v7
    s_cmp_ge_u32 s61, 4194304
    s_cbranch_scc1 Lkd4
    s_and_b64 exec, exec, vcc
    s_cbranch_execz Lkd4
    s_branch Lkp3
Lkd4:
    s_mov_b64 exec, -1
    v_cndmask_b32 v20, 0, v20, s[64:65]
    v_cndmask_b32 v21, 0, v21, s[64:65]
    v_cndmask_b32 v22, 0, v22, s[64:65]
LFCt0:
    v_max3_u32 v7, v12, v16, v20
    s_nop 1
    v_max_u32_dpp v7, v7, v7 quad_perm:[1,0,3,2] row_mask:0xf bank_mask:0xf
    s_nop 1
    v_max_u32_dpp v7, v7, v7 quad_perm:[2,3,0,1] row_mask:0xf bank_mask:0xf
    s_nop 1
    v_max_u32_dpp v8, v7, v7 row_ror:4 row_mask:0xf bank_mask:0xf
    v_min_u32_dpp v11, v7, v7 row_ror:4 row_mask:0xf bank_mask:0xf
    s_nop 0
    v_min_u32_dpp v8, v8, v8 row_ror:8 row_mask:0xf bank_mask:0xf
    v_max_u32_dpp v11, v11, v11 row_ror:8 row_mask:0xf bank_mask:0xf
    v_max_u32 v7, v8, v11
    s_nop 0
    v_readlane_b32 s16, v7, 0
    v_readlane_b32 s17, v7, 16
    v_readlane_b32 s18, v7, 32
    v_readlane_b32 s19, v7, 48
    s_min_u32 s16, s16, s17
    s_min_u32 s18, s18, s19
    s_min_u32 s62, s16, s18
    s_max_u32 s62, s62, 1
LFCl:
    s_mov_b32 s63, 0
    v_cmp_le_u32 s[16:17], s62, v12
    v_cmp_le_u32 s[18:19], s62, v16
    v_cmp_le_u32 s[20:21], s62, v20
    v_cmp_le_u32 s[22:23], s62, v13
    v_cmp_le_u32 s[24:25], s62, v17
    v_cmp_le_u32 s[26:27], s62, v21
    v_cmp_le_u32 s[28:29], s62, v14
    v_cmp_le_u32 s[30:31], s62, v18
    v_cmp_le_u32 s[32:33], s62, v22
    s_mov_b64 exec, s[16:17]
    v_mbcnt_lo_u32_b32 v50, exec_lo, 0
    s_bcnt1_i32_b64 s60, exec
    v_mbcnt_hi_u32_b32 v50, exec_hi, v50
    v_add_lshl_u32 v50, v50, s63, 2
    s_add_u32 s63, s63, s60
    ds_write_b32 v50, v12 offset:40960
Lce5:
    s_mov_b64 exec, s[18:19]
    v_mbcnt_lo_u32_b32 v50, exec_lo, 0
    s_bcnt1_i32_b64 s60, exec
    v_mbcnt_hi_u32_b32 v50, exec_hi, v50
    v_add_lshl_u32 v50, v50, s63, 2
    s_add_u32 s63, s63, s60
    ds_write_b32 v50, v16 offset:40960
Lce6:
    s_mov_b64 exec, s[20:21]
    v_mbcnt_lo_u32_b32 v50, exec_lo, 0
    s_bcnt1_i32_b64 s60, exec
    v_mbcnt_hi_u32_b32 v50, exec_hi, v50
    v_add_lshl_u32 v50, v50, s63, 2
    s_add_u32 s63, s63, s60
    ds_write_b32 v50, v20 offset:40960
Lce7:
    s_mov_b64 exec, s[22:23]
    s_cbranch_execz Lce8
    v_mbcnt_lo_u32_b32 v50, exec_lo, 0
    s_bcnt1_i32_b64 s60, exec
    v_mbcnt_hi_u32_b32 v50, exec_hi, v50
    v_add_lshl_u32 v50, v50, s63, 2
    s_add_u32 s63, s63, s60
    ds_write_b32 v50, v13 offset:40960
Lce8:
    s_mov_b64 exec, s[24:25]
    s_cbranch_execz Lce9
    v_mbcnt_lo_u32_b32 v50, exec_lo, 0
    s_bcnt1_i32_b64 s60, exec
    v_mbcnt_hi_u32_b32 v50, exec_hi, v50
    v_add_lshl_u32 v50, v50, s63, 2
    s_add_u32 s63, s63, s60
    ds_write_b32 v50, v17 offset:40960
Lce9:
    s_mov_b64 exec, s[26:27]
    s_cbranch_execz Lce10
    v_mbcnt_lo_u32_b32 v50, exec_lo, 0
    s_bcnt1_i32_b64 s60, exec
    v_mbcnt_hi_u32_b32 v50, exec_hi, v50
    v_add_lshl_u32 v50, v50, s63, 2
    s_add_u32 s63, s63, s60
    ds_write_b32 v50, v21 offset:40960
Lce10:
    s_mov_b64 exec, s[28:29]
    s_cbranch_execz Lce11
    v_mbcnt_lo_u32_b32 v50, exec_lo, 0
    s_bcnt1_i32_b64 s60, exec
    v_mbcnt_hi_u32_b32 v50, exec_hi, v50
    v_add_lshl_u32 v50, v50, s63, 2
    s_add_u32 s63, s63, s60
    ds_write_b32 v50, v14 offset:40960
Lce11:
    s_mov_b64 exec, s[30:31]
    s_cbranch_execz Lce12
    v_mbcnt_lo_u32_b32 v50, exec_lo, 0
    s_bcnt1_i32_b64 s60, exec
    v_mbcnt_hi_u32_b32 v50, exec_hi, v50
    v_add_lshl_u32 v50, v50, s63, 2
    s_add_u32 s63, s63, s60
    ds_write_b32 v50, v18 offset:40960
Lce12:
    s_mov_b64 exec, s[32:33]
    s_cbranch_execz Lce13
    v_mbcnt_lo_u32_b32 v50, exec_lo, 0
    s_bcnt1_i32_b64 s60, exec
    v_mbcnt_hi_u32_b32 v50, exec_hi, v50
    v_add_lshl_u32 v50, v50, s63, 2
    s_add_u32 s63, s63, s60
    ds_write_b32 v50, v22 offset:40960
Lce13:
    s_mov_b64 exec, -1
    s_cmp_eq_u32 s66, 0
    s_cbranch_scc1 LFCn
    s_cmp_ge_u32 s67, 1
    s_cbranch_scc1 Lkl14
    s_movk_i32 s60, 4192
    s_mov_b32 s61, 0
Lkp15:
    buffer_load_dwordx4 v[24:27], v4, s[8:11], s60 offen offset:16 sc1
    buffer_load_dwordx4 v[28:31], v5, s[8:11], s60 offen offset:16 sc1
    buffer_load_dwordx4 v[32:35], v6, s[8:11], s60 offen offset:16 sc1
    s_add_u32 s61, s61, 1
    s_waitcnt vmcnt(0)
    v_xor_b32 v7, s5, v27
    v_xor_b32 v8, s5, v31
    v_xor_b32 v11, s5, v35
    v_or3_b32 v7, v7, v8, v11
    v_cmp_ne_u32 vcc, 0, v7
    s_cmp_ge_u32 s61, 4194304
    s_cbranch_scc1 Lkd16
    s_and_b64 exec, exec, vcc
    s_cbranch_execz Lkd16
    s_branch Lkp15
Lkd16:
    s_mov_b64 exec, -1
    v_cndmask_b32 v32, 0, v32, s[64:65]
    v_cndmask_b32 v33, 0, v33, s[64:65]
    v_cndmask_b32 v34, 0, v34, s[64:65]
    s_mov_b32 s67, 1
Lkl14:
    v_cmp_le_u32 s[16:17], s62, v24
    v_cmp_le_u32 s[18:19], s62, v28
    v_cmp_le_u32 s[20:21], s62, v32
    v_cmp_le_u32 s[22:23], s62, v25
    v_cmp_le_u32 s[24:25], s62, v29
    v_cmp_le_u32 s[26:27], s62, v33
    v_cmp_le_u32 s[28:29], s62, v26
    v_cmp_le_u32 s[30:31], s62, v30
    v_cmp_le_u32 s[32:33], s62, v34
    s_mov_b64 exec, s[16:17]
    s_cbranch_execz Lce17
    v_mbcnt_lo_u32_b32 v50, exec_lo, 0
    s_bcnt1_i32_b64 s60, exec
    v_mbcnt_hi_u32_b32 v50, exec_hi, v50
    v_add_lshl_u32 v50, v50, s63, 2
    s_add_u32 s63, s63, s60
    ds_write_b32 v50, v24 offset:40960
Lce17:
    s_mov_b64 exec, s[18:19]
    s_cbranch_execz Lce18
    v_mbcnt_lo_u32_b32 v50, exec_lo, 0
    s_bcnt1_i32_b64 s60, exec
    v_mbcnt_hi_u32_b32 v50, exec_hi, v50
    v_add_lshl_u32 v50, v50, s63, 2
    s_add_u32 s63, s63, s60
    ds_write_b32 v50, v28 offset:40960
Lce18:
    s_mov_b64 exec, s[20:21]
    s_cbranch_execz Lce19
    v_mbcnt_lo_u32_b32 v50, exec_lo, 0
    s_bcnt1_i32_b64 s60, exec
    v_mbcnt_hi_u32_b32 v50, exec_hi, v50
    v_add_lshl_u32 v50, v50, s63, 2
    s_add_u32 s63, s63, s60
    ds_write_b32 v50, v32 offset:40960
Lce19:
    s_mov_b64 exec, s[22:23]
    s_cbranch_execz Lce20
    v_mbcnt_lo_u32_b32 v50, exec_lo, 0
    s_bcnt1_i32_b64 s60, exec
    v_mbcnt_hi_u32_b32 v50, exec_hi, v50
    v_add_lshl_u32 v50, v50, s63, 2
    s_add_u32 s63, s63, s60
    ds_write_b32 v50, v25 offset:40960
Lce20:
    s_mov_b64 exec, s[24:25]
    s_cbranch_execz Lce21
    v_mbcnt_lo_u32_b32 v50, exec_lo, 0
    s_bcnt1_i32_b64 s60, exec
    v_mbcnt_hi_u32_b32 v50, exec_hi, v50
    v_add_lshl_u32 v50, v50, s63, 2
    s_add_u32 s63, s63, s60
    ds_write_b32 v50, v29 offset:40960
Lce21:
    s_mov_b64 exec, s[26:27]
    s_cbranch_execz Lce22
    v_mbcnt_lo_u32_b32 v50, exec_lo, 0
    s_bcnt1_i32_b64 s60, exec
    v_mbcnt_hi_u32_b32 v50, exec_hi, v50
    v_add_lshl_u32 v50, v50, s63, 2
    s_add_u32 s63, s63, s60
    ds_write_b32 v50, v33 offset:40960
Lce22:
    s_mov_b64 exec, s[28:29]
    s_cbranch_execz Lce23
    v_mbcnt_lo_u32_b32 v50, exec_lo, 0
    s_bcnt1_i32_b64 s60, exec
    v_mbcnt_hi_u32_b32 v50, exec_hi, v50
    v_add_lshl_u32 v50, v50, s63, 2
    s_add_u32 s63, s63, s60
    ds_write_b32 v50, v26 offset:40960
Lce23:
    s_mov_b64 exec, s[30:31]
    s_cbranch_execz Lce24
    v_mbcnt_lo_u32_b32 v50, exec_lo, 0
    s_bcnt1_i32_b64 s60, exec
    v_mbcnt_hi_u32_b32 v50, exec_hi, v50
    v_add_lshl_u32 v50, v50, s63, 2
    s_add_u32 s63, s63, s60
    ds_write_b32 v50, v30 offset:40960
Lce24:
    s_mov_b64 exec, s[32:33]
    s_cbranch_execz Lce25
    v_mbcnt_lo_u32_b32 v50, exec_lo, 0
    s_bcnt1_i32_b64 s60, exec
    v_mbcnt_hi_u32_b32 v50, exec_hi, v50
    v_add_lshl_u32 v50, v50, s63, 2
    s_add_u32 s63, s63, s60
    ds_write_b32 v50, v34 offset:40960
Lce25:
    s_mov_b64 exec, -1
    s_cmp_ge_u32 s67, 2
    s_cbranch_scc1 Lkl26
    s_movk_i32 s60, 29696
    s_mov_b32 s61, 0
Lkp27:
    v_lshrrev_b32 v7, 3, v4
    buffer_load_dwordx4 v[36:39], v7, s[8:11], s60 offen sc1
    v_lshrrev_b32 v7, 3, v5
    buffer_load_dwordx4 v[40:43], v7, s[8:11], s60 offen sc1
    v_lshrrev_b32 v7, 3, v6
    buffer_load_dwordx4 v[44:47], v7, s[8:11], s60 offen sc1
    s_add_u32 s61, s61, 1
    s_waitcnt vmcnt(0)
    v_xor_b32 v7, s5, v39
    v_xor_b32 v8, s5, v43
    v_xor_b32 v11, s5, v47
    v_or3_b32 v7, v7, v8, v11
    v_cmp_ne_u32 vcc, 0, v7
    s_cmp_ge_u32 s61, 4194304
    s_cbranch_scc1 Lkd28
    s_and_b64 exec, exec, vcc
    s_cbranch_execz Lkd28
    s_branch Lkp27
Lkd28:
    s_mov_b64 exec, -1
    v_cndmask_b32 v44, 0, v44, s[64:65]
    v_cndmask_b32 v45, 0, v45, s[64:65]
    v_cndmask_b32 v46, 0, v46, s[64:65]
    s_mov_b32 s67, 2
Lkl26:
    v_cmp_le_u32 s[16:17], s62, v36
    v_cmp_le_u32 s[18:19], s62, v40
    v_cmp_le_u32 s[20:21], s62, v44
    v_cmp_le_u32 s[22:23], s62, v37
    v_cmp_le_u32 s[24:25], s62, v41
    v_cmp_le_u32 s[26:27], s62, v45
    s_mov_b64 exec, s[16:17]
    s_cbranch_execz Lce29
    v_mbcnt_lo_u32_b32 v50, exec_lo, 0
    s_bcnt1_i32_b64 s60, exec
    v_mbcnt_hi_u32_b32 v50, exec_hi, v50
    v_add_lshl_u32 v50, v50, s63, 2
    s_add_u32 s63, s63, s60
    ds_write_b32 v50, v36 offset:40960
Lce29:
    s_mov_b64 exec, s[18:19]
    s_cbranch_execz Lce30
    v_mbcnt_lo_u32_b32 v50, exec_lo, 0
    s_bcnt1_i32_b64 s60, exec
    v_mbcnt_hi_u32_b32 v50, exec_hi, v50
    v_add_lshl_u32 v50, v50, s63, 2
    s_add_u32 s63, s63, s60
    ds_write_b32 v50, v40 offset:40960
Lce30:
    s_mov_b64 exec, s[20:21]
    s_cbranch_execz Lce31
    v_mbcnt_lo_u32_b32 v50, exec_lo, 0
    s_bcnt1_i32_b64 s60, exec
    v_mbcnt_hi_u32_b32 v50, exec_hi, v50
    v_add_lshl_u32 v50, v50, s63, 2
    s_add_u32 s63, s63, s60
    ds_write_b32 v50, v44 offset:40960
Lce31:
    s_mov_b64 exec, s[22:23]
    s_cbranch_execz Lce32
    v_mbcnt_lo_u32_b32 v50, exec_lo, 0
    s_bcnt1_i32_b64 s60, exec
    v_mbcnt_hi_u32_b32 v50, exec_hi, v50
    v_add_lshl_u32 v50, v50, s63, 2
    s_add_u32 s63, s63, s60
    ds_write_b32 v50, v37 offset:40960
Lce32:
    s_mov_b64 exec, s[24:25]
    s_cbranch_execz Lce33
    v_mbcnt_lo_u32_b32 v50, exec_lo, 0
    s_bcnt1_i32_b64 s60, exec
    v_mbcnt_hi_u32_b32 v50, exec_hi, v50
    v_add_lshl_u32 v50, v50, s63, 2
    s_add_u32 s63, s63, s60
    ds_write_b32 v50, v41 offset:40960
Lce33:
    s_mov_b64 exec, s[26:27]
    s_cbranch_execz Lce34
    v_mbcnt_lo_u32_b32 v50, exec_lo, 0
    s_bcnt1_i32_b64 s60, exec
    v_mbcnt_hi_u32_b32 v50, exec_hi, v50
    v_add_lshl_u32 v50, v50, s63, 2
    s_add_u32 s63, s63, s60
    ds_write_b32 v50, v45 offset:40960
Lce34:
    s_mov_b64 exec, -1
LFCn:
    v_mov_b32 v65, 0
    s_cmp_gt_u32 s63, 32
    s_cbranch_scc1 LFCw
    ds_read_b32 v64, v52 offset:40960
    ds_read_b128 v[96:99], v53 offset:40960
    ds_read_b128 v[100:103], v53 offset:40992
    ds_read_b128 v[104:107], v53 offset:41024
    ds_read_b128 v[108:111], v53 offset:41056
    s_waitcnt lgkmcnt(2)
    v_cmp_gt_u32 s[16:17], v96, v64
    v_cmp_gt_u32 s[18:19], v97, v64
    v_cmp_gt_u32 s[20:21], v98, v64
    v_cmp_gt_u32 s[22:23], v99, v64
    v_addc_co_u32 v65, vcc, 0, v65, s[16:17]
    v_addc_co_u32 v65, vcc, 0, v65, s[18:19]
    v_addc_co_u32 v65, vcc, 0, v65, s[20:21]
    v_addc_co_u32 v65, vcc, 0, v65, s[22:23]
    v_cmp_gt_u32 s[16:17], v100, v64
    v_cmp_gt_u32 s[18:19], v101, v64
    v_cmp_gt_u32 s[20:21], v102, v64
    v_cmp_gt_u32 s[22:23], v103, v64
    v_addc_co_u32 v65, vcc, 0, v65, s[16:17]
    v_addc_co_u32 v65, vcc, 0, v65, s[18:19]
    v_addc_co_u32 v65, vcc, 0, v65, s[20:21]
    v_addc_co_u32 v65, vcc, 0, v65, s[22:23]
    s_cmp_le_u32 s63, 16
    s_cbranch_scc1 LFCv
    s_waitcnt lgkmcnt(1)
    v_cmp_gt_u32 s[16:17], v104, v64
    v_cmp_gt_u32 s[18:19], v105, v64
    v_cmp_gt_u32 s[20:21], v106, v64
    v_cmp_gt_u32 s[22:23], v107, v64
    v_addc_co_u32 v65, vcc, 0, v65, s[16:17]
    v_addc_co_u32 v65, vcc, 0, v65, s[18:19]
    v_addc_co_u32 v65, vcc, 0, v65, s[20:21]
    v_addc_co_u32 v65, vcc, 0, v65, s[22:23]
    s_cmp_le_u32 s63, 24
    s_cbranch_scc1 LFCv
    s_waitcnt lgkmcnt(0)
    v_cmp_gt_u32 s[16:17], v108, v64
    v_cmp_gt_u32 s[18:19], v109, v64
    v_cmp_gt_u32 s[20:21], v110, v64
    v_cmp_gt_u32 s[22:23], v111, v64
    v_addc_co_u32 v65, vcc, 0, v65, s[16:17]
    v_addc_co_u32 v65, vcc, 0, v65, s[18:19]
    v_addc_co_u32 v65, vcc, 0, v65, s[20:21]
    v_addc_co_u32 v65, vcc, 0, v65, s[22:23]
LFCv:
    v_mov_b32 v66, v65
    s_nop 1
    v_permlane32_swap_b32 v65, v66
    v_add_u32 v65, v65, v66
    s_branch LFCr
LFCw:
    ds_read_b32 v64, v9 offset:40960
    s_mov_b32 s61, 0
    s_min_u32 s60, s63, 64
    s_lshl_b32 s60, s60, 2
LFCm:
    v_mov_b32 v51, s61
    ds_read_b128 v[96:99], v51 offset:40960
    ds_read_b128 v[100:103], v51 offset:40976
    ds_read_b128 v[104:107], v51 offset:40992
    ds_read_b128 v[108:111], v51 offset:41008
    s_waitcnt lgkmcnt(3)
    v_cmp_gt_u32 s[16:17], v96, v64
    v_cmp_gt_u32 s[18:19], v97, v64
    v_cmp_gt_u32 s[20:21], v98, v64
    v_cmp_gt_u32 s[22:23], v99, v64
    v_addc_co_u32 v65, vcc, 0, v65, s[16:17]
    v_addc_co_u32 v65, vcc, 0, v65, s[18:19]
    v_addc_co_u32 v65, vcc, 0, v65, s[20:21]
    v_addc_co_u32 v65, vcc, 0, v65, s[22:23]
    s_waitcnt lgkmcnt(2)
    v_cmp_gt_u32 s[16:17], v100, v64
    v_cmp_gt_u32 s[18:19], v101, v64
    v_cmp_gt_u32 s[20:21], v102, v64
    v_cmp_gt_u32 s[22:23], v103, v64
    v_addc_co_u32 v65, vcc, 0, v65, s[16:17]
    v_addc_co_u32 v65, vcc, 0, v65, s[18:19]
    v_addc_co_u32 v65, vcc, 0, v65, s[20:21]
    v_addc_co_u32 v65, vcc, 0, v65, s[22:23]
    s_waitcnt lgkmcnt(1)
    v_cmp_gt_u32 s[16:17], v104, v64
    v_cmp_gt_u32 s[18:19], v105, v64
    v_cmp_gt_u32 s[20:21], v106, v64
    v_cmp_gt_u32 s[22:23], v107, v64
    v_addc_co_u32 v65, vcc, 0, v65, s[16:17]
    v_addc_co_u32 v65, vcc, 0, v65, s[18:19]
    v_addc_co_u32 v65, vcc, 0, v65, s[20:21]
    v_addc_co_u32 v65, vcc, 0, v65, s[22:23]
    s_waitcnt lgkmcnt(0)
    v_cmp_gt_u32 s[16:17], v108, v64
    v_cmp_gt_u32 s[18:19], v109, v64
    v_cmp_gt_u32 s[20:21], v110, v64
    v_cmp_gt_u32 s[22:23], v111, v64
    v_addc_co_u32 v65, vcc, 0, v65, s[16:17]
    v_addc_co_u32 v65, vcc, 0, v65, s[18:19]
    v_addc_co_u32 v65, vcc, 0, v65, s[20:21]
    v_addc_co_u32 v65, vcc, 0, v65, s[22:23]
    s_add_u32 s61, s61, 64
    s_cmp_lt_u32 s61, s60
    s_cbranch_scc1 LFCm
    s_cmp_le_u32 s63, 64
    s_cbranch_scc1 LFCr
    v_cmp_eq_u32 vcc, 7, v65
    s_nop 0
    s_ff1_i32_b64 s61, vcc
    v_readlane_b32 s62, v64, s61
LFCa:
    s_waitcnt lgkmcnt(0)
    ds_write_b32 v9, v10 offset:40960
    s_branch LFCl
LFCr:
    s_cmp_lg_u32 s66, 0
    s_cbranch_scc1 LFCz
    v_cmp_eq_u32 vcc, 7, v65
    v_max3_u32 v7, v14, v18, v22
    s_ff1_i32_b64 s61, vcc
    v_readlane_b32 s62, v64, s61
    s_mov_b32 s66, 1
    s_nop 0
    v_cmp_le_u32 vcc, s62, v7
    s_nop 0
    s_cbranch_vccnz LFCa
LFCz:
    s_cmp_eq_u32 s46, 0
    s_cbranch_scc1 LFCgo
    v_lshlrev_b32 v29, 2, v65
    v_cmp_gt_u32 vcc, 8, v65
    s_nop 0
    s_mov_b64 exec, vcc
    ds_write_b32 v29, v64 offset:1152
    s_mov_b64 exec, -1
    v_and_b32 v28, 7, v1
    v_lshlrev_b32 v29, 2, v28
    ds_read_b32 v34, v29 offset:1152
    s_mul_i32 s60, s47, 3
    v_lshrrev_b32 v30, 3, v1
    v_add_u32 v30, s60, v30
    s_movk_i32 s61, 160
    v_cmp_gt_u32 vcc, s61, v30
    s_nop 0
    s_and_b64 vcc, vcc, 0xffffff
    v_mul_u32_u24 v31, 7040, v30
    v_lshl_add_u32 v31, v28, 4, v31
    v_mov_b32 v35, s5
    s_waitcnt lgkmcnt(0)
    v_not_b32 v29, v34
    v_and_b32 v29, 0x7ff, v29
    v_mul_u32_u24 v29, 1280, v29
    v_lshl_add_u32 v29, v30, 3, v29
    s_mov_b64 exec, vcc
    buffer_load_dwordx2 v[32:33], v29, s[12:15], 0 offen
    s_mov_b32 s60, 51968
    s_waitcnt vmcnt(0)
    buffer_store_dwordx4 v[32:35], v31, s[8:11], s60 offen sc1
    s_mov_b64 exec, -1
    v_min_u32 v8, 848, v2
    s_movk_i32 s62, 28672
    s_cmp_lg_u32 s47, 0
    s_cbranch_scc1 LFCe0
    buffer_load_dword v11, v8, s[8:11], s62 offen sc1
LFCe0:
    s_barrier
    s_cmp_lg_u32 s47, 0
    s_cbranch_scc1 LFCe4
    s_waitcnt vmcnt(0)
    v_cmp_ne_u32 vcc, s5, v11
    s_nop 0
    s_cbranch_vccz LFCe3
    s_barrier
    s_mov_b32 s61, 0
LFCe1:
    buffer_load_dword v11, v8, s[8:11], s62 offen sc1
    s_add_u32 s61, s61, 1
    s_waitcnt vmcnt(0)
    v_cmp_ne_u32 vcc, s5, v11
    s_cmp_ge_u32 s61, 4194304
    s_cbranch_scc1 LFCe2
    s_cbranch_vccnz LFCe1
LFCe2:
    s_mov_b64 exec, 1
    global_store_dword v10, v35, s[44:45] sc1
    s_branch Lfin
LFCe3:
    s_mov_b64 exec, 1
    global_store_dword v10, v35, s[44:45] sc1
    s_mov_b64 exec, -1
LFCe4:
    s_barrier
    s_branch Lfin
LSP:
    s_cmp_ge_u32 s58, 171
    s_cbranch_scc1 LSt
    s_cmp_ge_u32 s4, 4
    s_cbranch_scc1 LSt
    buffer_load_dwordx4 v[10:13], v2, s[12:15], s6 offen offset:0
    buffer_load_dword v14, v3, s[12:15], s6 offen offset:0
    buffer_load_dwordx4 v[16:19], v2, s[12:15], s6 offen offset:1280
    buffer_load_dword v20, v3, s[12:15], s6 offen offset:1280
    buffer_load_dwordx4 v[22:25], v2, s[12:15], s6 offen offset:2560
    buffer_load_dword v26, v3, s[12:15], s6 offen offset:2560
    global_load_dwordx4 v[28:31], v2, s[32:33]
    global_load_dword v32, v3, s[32:33]
    s_load_dword s5, s[44:45], 0
    s_waitcnt vmcnt(0)
    s_mov_b32 s62, 0x3F803F80
    s_mov_b32 s63, 0x3ACCCCCD
    v_dot2_f32_bf16 v36, v10, s62, 0
    v_dot2_f32_bf16 v40, v10, v10, 0
    v_dot2_f32_bf16 v44, v10, v28, 0
    v_dot2_f32_bf16 v37, v16, s62, 0
    v_dot2_f32_bf16 v41, v16, v16, 0
    v_dot2_f32_bf16 v45, v16, v28, 0
    v_dot2_f32_bf16 v38, v22, s62, 0
    v_dot2_f32_bf16 v42, v22, v22, 0
    v_dot2_f32_bf16 v46, v22, v28, 0
    v_dot2_f32_bf16 v39, v28, s62, 0
    v_dot2_f32_bf16 v36, v11, s62, v36
    v_dot2_f32_bf16 v40, v11, v11, v40
    v_dot2_f32_bf16 v44, v11, v29, v44
    v_dot2_f32_bf16 v37, v17, s62, v37
    v_dot2_f32_bf16 v41, v17, v17, v41
    v_dot2_f32_bf16 v45, v17, v29, v45
    v_dot2_f32_bf16 v38, v23, s62, v38
    v_dot2_f32_bf16 v42, v23, v23, v42
    v_dot2_f32_bf16 v46, v23, v29, v46
    v_dot2_f32_bf16 v39, v29, s62, v39
    v_dot2_f32_bf16 v36, v12, s62, v36
    v_dot2_f32_bf16 v40, v12, v12, v40
    v_dot2_f32_bf16 v44, v12, v30, v44
    v_dot2_f32_bf16 v37, v18, s62, v37
    v_dot2_f32_bf16 v41, v18, v18, v41
    v_dot2_f32_bf16 v45, v18, v30, v45
    v_dot2_f32_bf16 v38, v24, s62, v38
    v_dot2_f32_bf16 v42, v24, v24, v42
    v_dot2_f32_bf16 v46, v24, v30, v46
    v_dot2_f32_bf16 v39, v30, s62, v39
    v_dot2_f32_bf16 v36, v13, s62, v36
    v_dot2_f32_bf16 v40, v13, v13, v40
    v_dot2_f32_bf16 v44, v13, v31, v44
    v_dot2_f32_bf16 v37, v19, s62, v37
    v_dot2_f32_bf16 v41, v19, v19, v41
    v_dot2_f32_bf16 v45, v19, v31, v45
    v_dot2_f32_bf16 v38, v25, s62, v38
    v_dot2_f32_bf16 v42, v25, v25, v42
    v_dot2_f32_bf16 v46, v25, v31, v46
    v_dot2_f32_bf16 v39, v31, s62, v39
    v_dot2_f32_bf16 v36, v14, s62, v36
    v_dot2_f32_bf16 v40, v14, v14, v40
    v_dot2_f32_bf16 v44, v14, v32, v44
    v_dot2_f32_bf16 v37, v20, s62, v37
    v_dot2_f32_bf16 v41, v20, v20, v41
    v_dot2_f32_bf16 v45, v20, v32, v45
    v_dot2_f32_bf16 v38, v26, s62, v38
    v_dot2_f32_bf16 v42, v26, v26, v42
    v_dot2_f32_bf16 v46, v26, v32, v46
    v_dot2_f32_bf16 v39, v32, s62, v39
    v_lshrrev_b32 v50, 4, v1
    v_cmp_eq_u32 vcc, 3, v50
    s_and_b32 s60, s4, 3
    s_mul_i32 s61, s60, 3
    s_lshl_b32 s60, s60, 4
    s_add_u32 s60, s60, 0
    v_lshl_add_u32 v49, v50, 2, s60
    v_add_u32 v48, s61, v50
    v_cndmask_b32 v48, v48, 30, vcc
    v_and_b32 v51, 1, v48
    v_lshrrev_b32 v48, 1, v48
    v_lshlrev_b32 v48, 4, v48
    v_add_u32 v48, 0, v48
    v_lshl_add_u32 v52, v51, 2, v48
    v_lshl_add_u32 v53, v51, 1, v48
    v_permlane32_swap_b32 v36, v38
    v_permlane32_swap_b32 v37, v39
    v_permlane32_swap_b32 v40, v42
    v_permlane32_swap_b32 v41, v43
    v_permlane32_swap_b32 v44, v46
    v_permlane32_swap_b32 v45, v47
    v_add_f32 v36, v36, v38
    v_add_f32 v37, v37, v39
    v_add_f32 v40, v40, v42
    v_add_f32 v41, v41, v43
    v_add_f32 v44, v44, v46
    v_add_f32 v45, v45, v47
    v_permlane16_swap_b32 v36, v37
    v_permlane16_swap_b32 v40, v41
    v_permlane16_swap_b32 v44, v45
    v_add_f32 v36, v36, v37
    v_add_f32 v40, v40, v41
    v_add_f32 v44, v44, v45
    v_add_f32_dpp v36, v36, v36 row_ror:8 row_mask:0xf bank_mask:0xf
    v_add_f32_dpp v40, v40, v40 row_ror:8 row_mask:0xf bank_mask:0xf
    v_add_f32_dpp v44, v44, v44 row_ror:8 row_mask:0xf bank_mask:0xf
    v_add_f32_dpp v36, v36, v36 row_ror:4 row_mask:0xf bank_mask:0xf
    v_add_f32_dpp v40, v40, v40 row_ror:4 row_mask:0xf bank_mask:0xf
    v_add_f32_dpp v44, v44, v44 row_ror:4 row_mask:0xf bank_mask:0xf
    v_add_f32_dpp v36, v36, v36 row_ror:2 row_mask:0xf bank_mask:0xf
    v_add_f32_dpp v40, v40, v40 row_ror:2 row_mask:0xf bank_mask:0xf
    v_add_f32_dpp v44, v44, v44 row_ror:2 row_mask:0xf bank_mask:0xf
    v_add_f32_dpp v36, v36, v36 row_ror:1 row_mask:0xf bank_mask:0xf
    v_add_f32_dpp v40, v40, v40 row_ror:1 row_mask:0xf bank_mask:0xf
    v_add_f32_dpp v44, v44, v44 row_ror:1 row_mask:0xf bank_mask:0xf
    v_readlane_b32 s60, v36, 48
    v_mul_f32 v36, s63, v36
    v_mul_f32 v40, s63, v40
    v_fma_f32 v40, -v36, v36, v40
    v_max_f32 v40, 0, v40
    v_cvt_pk_bf16_f32 v40, v40, v40
    v_and_b32 v40, 0xffff0000, v40
    v_add_f32 v40, 0x3727C5AC, v40
    v_cvt_pk_bf16_f32 v40, v40, v40
    v_and_b32 v40, 0xffff0000, v40
    v_sqrt_f32 v40, v40
    v_add_u32 v41, s46, v50
    s_movk_i32 s63, 0x800
    v_cvt_pk_bf16_f32 v37, v36, v40
    v_cmp_gt_u32 s[100:101], s63, v41
    v_sub_u32 v41, 0xfff, v41
    v_lshlrev_b32 v36, 16, v37
    v_and_b32 v40, 0xffff0000, v37
    v_rcp_f32 v40, v40
    ds_write_b16 v53, v37 offset:8
    v_fma_f32 v44, -v36, s60, v44
    v_mul_f32 v44, v44, v40
    ds_write_b32 v52, v40
    v_cvt_pk_bf16_f32 v44, v44, v44
    v_and_b32 v44, 0xffff0000, v44
    v_ashrrev_i32 v37, 31, v44
    v_or_b32 v37, 0x80000000, v37
    v_and_b32 v37, 0xffff0000, v37
    v_xor_b32 v44, v44, v37
    v_or_b32 v44, v44, v41
    v_cndmask_b32 v44, 0, v44, s[100:101]
    ds_write_b32 v49, v44 offset:160
    v_mov_b32 v36, 0
    v_mov_b32 v37, 1
    s_waitcnt lgkmcnt(0)
    s_mul_i32 s5, s5, 0x9E3779B1
    s_add_u32 s5, s5, 0x3C6EF35F
    s_mov_b64 exec, 1
    ds_add_rtn_u32 v37, v36, v37 offset:224
    s_mov_b64 exec, -1
    v_and_b32 v40, 15, v1
    v_lshl_add_u32 v40, v40, 2, v36
    ds_read_b32 v41, v40 offset:160
    v_lshl_add_u32 v42, v50, 4, v36
    ds_read_b128 v[52:55], v42 offset:160
    s_waitcnt lgkmcnt(2)
    v_readfirstlane_b32 s60, v37
    s_nop 0
    s_cmp_lg_u32 s60, 3
    s_cbranch_scc1 Llnp35
    v_mov_b32 v44, 0
    s_waitcnt lgkmcnt(0)
    v_cmp_gt_u32 s[60:61], v52, v41
    v_cmp_gt_u32 s[62:63], v53, v41
    v_cmp_gt_u32 s[100:101], v54, v41
    v_addc_co_u32 v44, vcc, 0, v44, s[60:61]
    v_addc_co_u32 v44, vcc, 0, v44, s[62:63]
    v_addc_co_u32 v44, vcc, 0, v44, s[100:101]
    v_mov_b32 v45, v44
    s_nop 1
    v_permlane32_swap_b32 v44, v45
    v_add_u32 v44, v44, v45
    v_mov_b32 v45, v44
    s_nop 1
    v_permlane16_swap_b32 v44, v45
    v_add_u32 v44, v44, v45
    v_mul_u32_u24 v45, 11, v44
    v_lshrrev_b32 v45, 5, v45
    v_add_u32 v44, v44, v45
    v_lshl_add_u32 v44, v44, 2, v36
    s_mov_b64 exec, 0x7777
    ds_write_b32 v44, v41 offset:96
    s_mov_b64 exec, 0x1ff
    v_lshlrev_b32 v40, 4, v1
    v_add_u32 v41, v40, v36
    s_mul_i32 s61, s58, 112
    s_sub_u32 s61, 36864, s61
    v_writelane_b32 v40, s61, 6
    ds_read_b128 v[52:55], v41
    s_mul_i32 s61, s58, 112
    s_sub_u32 s61, 25600, s61
    v_writelane_b32 v40, s61, 8
    s_lshl_b32 s60, s58, 7
    s_add_u32 s60, s60, 4096
    s_waitcnt lgkmcnt(0)
    v_mov_b32 v55, s5
    buffer_store_dwordx4 v[52:55], v40, s[8:11], s60 offen sc1
    s_mov_b64 exec, -1
Llnp35:
LSw:
    s_barrier
    s_branch Lfin
LSt:
    s_and_b32 s60, s4, 1
    s_cmp_eq_u32 s60, 0
    s_cselect_b32 s96, s34, s36
    s_cselect_b32 s97, s35, s37
    s_mov_b32 s98, 2211840
    s_mov_b32 s99, 0x00020000
    s_lshl_b32 s68, s68, 7
    s_mov_b32 s61, 524288
    s_cmp_eq_u32 s69, 2
    s_cselect_b32 s61, 524288, s61
    s_cmp_eq_u32 s69, 4
    s_cselect_b32 s61, 262144, s61
    s_cmp_eq_u32 s69, 5
    s_cselect_b32 s61, 209716, s61
    s_lshr_b32 s60, s4, 1
    s_sub_u32 s62, s60, 2
    s_mul_i32 s62, s62, s65
    s_add_u32 s62, s62, s59
    s_sub_u32 s63, s65, s57
    s_mul_i32 s63, s63, s60
    s_add_u32 s63, s63, s59
    s_sub_u32 s63, s63, s57
    s_add_u32 s63, s63, s65
    s_add_u32 s63, s63, s65
    s_cmp_ge_u32 s4, 4
    s_cselect_b32 s60, s62, s63
    s_lshl_b32 s60, s60, 6
    s_lshl_b32 s62, s65, 1
    s_sub_u32 s62, s62, s57
    s_lshl_b32 s62, s62, 7
    v_add_u32 v5, s60, v1
    v_mul_u32_u24 v6, s61, v5
    v_lshrrev_b32 v6, 20, v6
    v_mul_u32_u24 v7, s69, v6
    v_sub_u32 v5, v5, v7
    v_mul_u32_u24 v7, 820, v6
    v_lshrrev_b32 v7, 16, v7
    v_mul_u32_u24 v8, 80, v7
    v_sub_u32 v8, v6, v8
    v_lshl_add_u32 v8, v8, 3, v7
    v_add_u32 v8, 3, v8
    v_mul_u32_u24 v8, 3456, v8
    v_lshl_add_u32 v88, v5, 7, v8
    v_cmp_le_u32 vcc, 400, v6
    v_mov_b32 v7, 0x7fffffff
    s_nop 0
    v_cndmask_b32 v88, v88, v7, vcc
    s_add_u32 s60, s60, s62
    v_add_u32 v5, s60, v1
    v_mul_u32_u24 v6, s61, v5
    v_lshrrev_b32 v6, 20, v6
    v_mul_u32_u24 v7, s69, v6
    v_sub_u32 v5, v5, v7
    v_mul_u32_u24 v7, 820, v6
    v_lshrrev_b32 v7, 16, v7
    v_mul_u32_u24 v8, 80, v7
    v_sub_u32 v8, v6, v8
    v_lshl_add_u32 v8, v8, 3, v7
    v_add_u32 v8, 3, v8
    v_mul_u32_u24 v8, 3456, v8
    v_lshl_add_u32 v89, v5, 7, v8
    v_cmp_le_u32 vcc, 400, v6
    v_mov_b32 v7, 0x7fffffff
    s_nop 0
    v_cndmask_b32 v89, v89, v7, vcc
    s_add_u32 s60, s60, s62
    buffer_load_dword v250, v88, s[96:99], s68 offen
    s_cmp_ge_u32 s58, 171
    s_cbranch_scc1 LSr
    s_barrier
LSr:
    buffer_load_dword v250, v89, s[96:99], s68 offen
    s_branch Lfin
Lfin:
Lend:
    s_endpgm
.section .rodata,"a"
.p2align 6
.amdhsa_kernel recurrent_scan__ssm_conv_s4d__moe_arch_mod__prompt_kernel
  .amdhsa_next_free_vgpr 256
  .amdhsa_next_free_sgpr 102
  .amdhsa_accum_offset 256
  .amdhsa_group_segment_fixed_size 0
  .amdhsa_kernarg_size 120
  .amdhsa_user_sgpr_count 2
  .amdhsa_user_sgpr_kernarg_segment_ptr 1
  .amdhsa_system_sgpr_workgroup_id_x 1
.end_amdhsa_kernel
```
